```python
import torch

def _softmax(x, axis=-1):
    return torch.softmax(x, dim=axis)
def _gelu(x):
    return torch.nn.functional.gelu(x, approximate="tanh")
def _silu(x):
    return torch.nn.functional.silu(x)
def _sigmoid(x):
    return torch.sigmoid(x)
def _layernorm(x, axis=-1, eps=1e-5):
    m = x.mean(dim=axis, keepdim=True)
    v = x.var(dim=axis, keepdim=True, unbiased=False)
    return (x - m) / torch.sqrt(v + eps)
def _scatter_add(tgt, idx, src, axis=0):
    return tgt.clone().index_add_(axis, idx, src)
def _segment_sum(src, seg, n):
    out = torch.zeros((n,) + src.shape[1:], dtype=src.dtype)
    return out.index_add_(0, seg, src)
def _pad(x, pw):
    flat = tuple(v for pair in reversed(pw) for v in pair)
    return torch.nn.functional.pad(x, flat)

kernel_name = 'recurrent_scan__mha_block_cached__dense_activation_relu__decode'

def setup_inputs():

    _w = (lambda a: (lambda t: t.to(torch.bfloat16) if t.is_floating_point() else t)(torch.as_tensor(a)))
    def _A_setup():
        B, Sq, D = 2, 1, 640
        H, Sk, Dh = 32, 4096, 192
        return {
            "x": _w((lambda *s: torch.randn(*s, dtype=torch.bfloat16) * 0.05)(B, Sq, D)),
            "k_cache": _w((lambda *s: torch.randn(*s, dtype=torch.bfloat16) * 1.6)(B, H, Sk, Dh)),
            "v_cache": _w((lambda *s: torch.randn(*s, dtype=torch.bfloat16) * 0.2)(B, H, Sk, Dh)),
            "wq": _w((lambda *s: torch.randn(*s, dtype=torch.bfloat16) * 1.6)(D, H * Dh) * (D ** -0.5)),
            "wo": _w((lambda *s: torch.randn(*s, dtype=torch.bfloat16) * 0.2)(H * Dh, D) * ((H * Dh) ** -0.5)),
        }
    _A_in = _A_setup()

    def _B_setup():
        B, S, D, Dff = 2, 1, 640, 1536
        return {
            "x": _w((lambda *s: torch.randn(*s, dtype=torch.bfloat16) * 0.05)(B, S, D)),
            "w1": _w((lambda *s: torch.randn(*s, dtype=torch.bfloat16) * 0.1)(D, Dff)),
            "w2": _w((lambda *s: torch.randn(*s, dtype=torch.bfloat16) * 0.1)(Dff, D)),
        }
    _B_in = _B_setup()

    return {
        "A_x": _A_in["x"],
        "A_k_cache": _A_in["k_cache"],
        "A_v_cache": _A_in["v_cache"],
        "A_wq": _A_in["wq"],
        "A_wo": _A_in["wo"],
        "B_x": _B_in["x"],
        "B_w1": _B_in["w1"],
        "B_w2": _B_in["w2"],
    }

def reference(A_x, A_k_cache, A_v_cache, A_wq, A_wo, B_x, B_w1, B_w2):
    def _A_ref(x, k_cache, v_cache, wq, wo):
        B, Sq, D = x.shape
        H, Dh = 32, 192
        q = (lambda x, *d: x.permute(*d))((x @ wq).reshape(B, Sq, H, Dh), 0, 2, 1, 3)
        scores = torch.einsum("bhqd,bhkd->bhqk", q, k_cache) * (Dh ** -0.5)
        p = _softmax(scores, axis=-1)
        o = torch.einsum("bhqk,bhkd->bhqd", p, v_cache)
        return (lambda x, *d: x.permute(*d))(o, 0, 2, 1, 3).reshape(B, Sq, H * Dh) @ wo

    def _B_ref(x, w1, w2):
        h = torch.einsum("bsd,df->bsf", x, w1)
        zero = torch.zeros_like(h)
        h = torch.maximum(h, zero)
        return torch.einsum("bsf,fd->bsd", h, w2)

    x = A_x
    xn = _layernorm(x, axis=-1)
    s = _A_ref(xn, A_k_cache, A_v_cache, A_wq, A_wo)
    g = _silu(_B_ref(xn, B_w1, B_w2))
    return x + s * g
```

```asm
; @launch grid=(256,1,1) block=(512,1,1) lds=69632
.amdgcn_target "amdgcn-amd-amdhsa--gfx950"
.text
.globl recurrent_scan__mha_block_cached__dense_activation_relu__decode_kernel
.p2align 8
.type recurrent_scan__mha_block_cached__dense_activation_relu__decode_kernel,@function
recurrent_scan__mha_block_cached__dense_activation_relu__decode_kernel:
  s_cmp_ge_u32 s2, 256
  s_cbranch_scc1 L_end
  s_load_dwordx16 s[4:19], s[0:1], 0
  s_load_dwordx2 s[20:21], s[0:1], 64
  s_load_dwordx2 s[22:23], s[0:1], 80
  v_lshrrev_b32 v1, 6, v0
  v_and_b32 v0, 63, v0
  v_readfirstlane_b32 s24, v1
  s_lshr_b32 s61, s2, 3
  s_lshr_b32 s25, s2, 3
  s_and_b32 s26, s2, 7
  s_lshr_b32 s27, s26, 2
  s_and_b32 s28, s26, 3
  s_lshl_b32 s29, s27, 5
  s_add_u32 s29, s29, s25
  s_cmp_ge_u32 s24, 4
  s_cbranch_scc1 L_helper1
L_stream:
  v_lshrrev_b32 v1, 3, v0
  v_mul_u32_u24 v1, 384, v1
  v_and_b32 v2, 7, v0
  v_lshl_add_u32 v1, v2, 4, v1
  s_mul_i32 s44, s24, 3072
  v_add_u32 v1, s44, v1
  s_mul_i32 s44, s28, 12288
  v_add_u32 v1, s44, v1
  s_mul_i32 s44, s29, 1572864
  s_lshr_b32 s50, s29, 0
  s_mul_i32 s50, s50, 7
  s_mov_b32 s34, 1572864
  s_mov_b32 s35, 0x20000
  s_waitcnt lgkmcnt(0)
  s_add_u32 s32, s6, s44
  s_addc_u32 s33, s7, 0
  s_and_b32 s50, s50, 31
  s_mul_i32 s45, s50, 49152
  s_add_u32 s50, s50, 1
  buffer_load_dwordx4 v[80:83], v1, s[32:35], s45 offen offset:0 nt
  buffer_load_dwordx4 v[84:87], v1, s[32:35], s45 offen offset:128 nt
  buffer_load_dwordx4 v[88:91], v1, s[32:35], s45 offen offset:256 nt
  s_and_b32 s50, s50, 31
  s_mul_i32 s45, s50, 49152
  s_add_u32 s50, s50, 1
  buffer_load_dwordx4 v[92:95], v1, s[32:35], s45 offen offset:0 nt
  buffer_load_dwordx4 v[96:99], v1, s[32:35], s45 offen offset:128 nt
  buffer_load_dwordx4 v[100:103], v1, s[32:35], s45 offen offset:256 nt
  s_branch L_stream2
L_helper1:
  s_sub_u32 s24, s24, 4
  s_cmp_lg_u32 s24, 3
  s_cbranch_scc1 L_pf_done
  s_getpc_b64 s[52:53]
L_pc:
  s_sub_u32 s52, s52, L_pc-recurrent_scan__mha_block_cached__dense_activation_relu__decode_kernel
  s_subb_u32 s53, s53, 0
  s_mov_b32 s54, L_code_end-recurrent_scan__mha_block_cached__dense_activation_relu__decode_kernel
  s_mov_b32 s55, 0x20000
  v_lshlrev_b32 v2, 7, v0
  s_lshl_b32 s56, s61, 10
  s_mov_b64 exec, 0xff
  buffer_load_dword v210, v2, s[52:55], s56 offen
  s_mov_b64 exec, -1
L_pf_done:
  v_lshrrev_b32 v2, 5, v0
  v_and_b32 v3, 31, v0
  v_mul_u32_u24 v8, 1280, v2
  v_lshl_add_u32 v8, v3, 3, v8
  s_and_b32 s44, s26, 1
  s_mul_i32 s44, s44, 320
  s_mul_i32 s45, s24, 80
  s_add_u32 s44, s44, s45
  v_lshrrev_b32 v10, 3, v0
  v_mul_u32_u24 v10, 10, v10
  v_add_u32 v10, s44, v10
  s_lshr_b32 s45, s26, 1
  s_mul_i32 s46, s25, 384
  s_lshl_b32 s47, s45, 7
  s_add_u32 s46, s46, s47
  s_lshl_b32 s47, s25, 7
  s_cmp_lt_u32 s25, 24
  s_cselect_b32 s48, 1966080, s47
  s_cmp_eq_u32 s45, 3
  s_cselect_b32 s46, s47, s46
  s_cselect_b32 s48, s48, 7864320
  s_cselect_b32 s49, 0, 2
  s_lshl_b32 s49, 3072, s49
  s_sub_u32 s38, s48, s46
  s_mov_b32 s39, 0x20000
  s_mov_b32 s34, 2560
  s_mov_b32 s35, 0x20000
  v_mul_lo_u32 v11, v10, s49
  v_and_b32 v12, 7, v0
  v_lshl_add_u32 v11, v12, 4, v11
  v_mov_b32 v13, 0
  v_lshlrev_b32 v14, 2, v0
  ds_write_b32 v14, v13 offset:10752
  s_cmp_eq_u32 s45, 3
  s_waitcnt lgkmcnt(0)
  s_load_dwordx2 s[30:31], s[22:23], 0
  s_cselect_b32 s36, s16, s10
  s_cselect_b32 s37, s17, s11
  s_mov_b32 s32, s4
  s_mov_b32 s33, s5
  s_add_u32 s36, s36, s46
  s_addc_u32 s37, s37, 0
  buffer_load_dwordx2 v[16:17], v8, s[32:35], 0 offen offset:0
  buffer_load_dwordx2 v[18:19], v8, s[32:35], 0 offen offset:256
  buffer_load_dwordx2 v[20:21], v8, s[32:35], 0 offen offset:512
  buffer_load_dwordx2 v[22:23], v8, s[32:35], 0 offen offset:768
  buffer_load_dwordx2 v[24:25], v8, s[32:35], 0 offen offset:1024
  s_mov_b32 s50, 0
  buffer_load_dwordx4 v[64:67], v11, s[36:39], s50 offen nt
  s_add_u32 s50, s50, s49
  buffer_load_dwordx4 v[68:71], v11, s[36:39], s50 offen nt
  s_add_u32 s50, s50, s49
  buffer_load_dwordx4 v[72:75], v11, s[36:39], s50 offen nt
  s_add_u32 s50, s50, s49
  buffer_load_dwordx4 v[76:79], v11, s[36:39], s50 offen nt
  s_add_u32 s50, s50, s49
  buffer_load_dwordx4 v[80:83], v11, s[36:39], s50 offen nt
  s_add_u32 s50, s50, s49
  buffer_load_dwordx4 v[84:87], v11, s[36:39], s50 offen nt
  s_add_u32 s50, s50, s49
  buffer_load_dwordx4 v[88:91], v11, s[36:39], s50 offen nt
  s_add_u32 s50, s50, s49
  buffer_load_dwordx4 v[92:95], v11, s[36:39], s50 offen nt
  s_add_u32 s50, s50, s49
  buffer_load_dwordx4 v[96:99], v11, s[36:39], s50 offen nt
  s_add_u32 s50, s50, s49
  buffer_load_dwordx4 v[100:103], v11, s[36:39], s50 offen nt
  s_waitcnt lgkmcnt(0)
  s_barrier
  s_branch L_helper2
L_stream2:
  s_mov_b32 s38, 1572864
  s_mov_b32 s39, 0x20000
  s_load_dwordx2 s[30:31], s[22:23], 0
  s_add_u32 s36, s8, s44
  s_addc_u32 s37, s9, 0
  s_barrier
  v_and_b32 v2, 1, v0
  v_lshlrev_b32 v2, 4, v2
  v_mov_b32 v3, 0xffff
  v_lshlrev_b32 v3, v2, v3
  v_bfe_u32 v2, v0, 1, 2
  v_cmp_eq_u32 vcc, 0, v2
  s_nop 1
  v_cndmask_b32 v4, 0, v3, vcc
  v_cmp_eq_u32 vcc, 1, v2
  s_nop 1
  v_cndmask_b32 v5, 0, v3, vcc
  v_cmp_eq_u32 vcc, 2, v2
  s_nop 1
  v_cndmask_b32 v6, 0, v3, vcc
  v_cmp_eq_u32 vcc, 3, v2
  s_nop 1
  v_cndmask_b32 v7, 0, v3, vcc
  s_mov_b32 s40, s22
  s_mov_b32 s41, s23
  s_mov_b32 s42, 1413120
  s_mov_b32 s43, 0x20000
  s_mov_b32 s46, 0x3d93cd3a
  s_mov_b32 s47, 0x3fb8aa3b
  v_and_b32 v2, 7, v0
  v_lshlrev_b32 v2, 4, v2
  v_mov_b32 v248, 0
  v_mov_b32 v249, 1
  s_lshl_b32 s49, s24, 3
  v_mov_b32 v250, s49
  s_mov_b32 s54, 0
  s_mov_b32 s58, 0
  s_mov_b32 s66, 0
  s_mov_b32 s67, 0
  s_waitcnt vmcnt(4)
  s_and_b32 s50, s50, 31
  s_mul_i32 s45, s50, 49152
  s_add_u32 s50, s50, 1
  buffer_load_dwordx4 v[104:107], v1, s[32:35], s45 offen offset:0 nt
  s_waitcnt vmcnt(4)
  buffer_load_dwordx4 v[108:111], v1, s[32:35], s45 offen offset:128 nt
  s_waitcnt vmcnt(4)
  buffer_load_dwordx4 v[112:115], v1, s[32:35], s45 offen offset:256 nt
  s_waitcnt vmcnt(4)
  s_and_b32 s50, s50, 31
  s_mul_i32 s45, s50, 49152
  s_add_u32 s50, s50, 1
  buffer_load_dwordx4 v[116:119], v1, s[32:35], s45 offen offset:0 nt
  s_waitcnt vmcnt(4)
  buffer_load_dwordx4 v[120:123], v1, s[32:35], s45 offen offset:128 nt
  s_waitcnt vmcnt(4)
  buffer_load_dwordx4 v[124:127], v1, s[32:35], s45 offen offset:256 nt
  s_waitcnt vmcnt(4)
  s_and_b32 s50, s50, 31
  s_mul_i32 s45, s50, 49152
  s_add_u32 s50, s50, 1
  buffer_load_dwordx4 v[128:131], v1, s[32:35], s45 offen offset:0 nt
  s_waitcnt vmcnt(4)
  buffer_load_dwordx4 v[132:135], v1, s[32:35], s45 offen offset:128 nt
  s_waitcnt vmcnt(4)
  buffer_load_dwordx4 v[136:139], v1, s[32:35], s45 offen offset:256 nt
  s_waitcnt vmcnt(4)
  s_and_b32 s50, s50, 31
  s_mul_i32 s45, s50, 49152
  s_add_u32 s50, s50, 1
  buffer_load_dwordx4 v[140:143], v1, s[32:35], s45 offen offset:0 nt
  s_waitcnt vmcnt(4)
  buffer_load_dwordx4 v[144:147], v1, s[32:35], s45 offen offset:128 nt
  s_waitcnt vmcnt(4)
  buffer_load_dwordx4 v[148:151], v1, s[32:35], s45 offen offset:256 nt
  s_waitcnt vmcnt(4)
  s_and_b32 s50, s50, 31
  s_mul_i32 s45, s50, 49152
  s_add_u32 s50, s50, 1
  buffer_load_dwordx4 v[152:155], v1, s[32:35], s45 offen offset:0 nt
  s_waitcnt vmcnt(4)
  buffer_load_dwordx4 v[156:159], v1, s[32:35], s45 offen offset:128 nt
  s_waitcnt vmcnt(4)
  buffer_load_dwordx4 v[160:163], v1, s[32:35], s45 offen offset:256 nt
  s_mov_b64 exec, 1
  ds_add_u32 v248, v249 offset:10804
  s_mov_b64 exec, -1
  s_waitcnt vmcnt(4)
  s_and_b32 s50, s50, 31
  s_mul_i32 s45, s50, 49152
  s_add_u32 s50, s50, 1
  buffer_load_dwordx4 v[164:167], v1, s[32:35], s45 offen offset:0 nt
  s_waitcnt vmcnt(4)
  buffer_load_dwordx4 v[168:171], v1, s[32:35], s45 offen offset:128 nt
  s_waitcnt vmcnt(4)
  buffer_load_dwordx4 v[172:175], v1, s[32:35], s45 offen offset:256 nt
  s_waitcnt vmcnt(4)
  s_and_b32 s50, s50, 31
  s_mul_i32 s45, s50, 49152
  s_add_u32 s50, s50, 1
  buffer_load_dwordx4 v[176:179], v1, s[32:35], s45 offen offset:0 nt
  s_waitcnt vmcnt(4)
  buffer_load_dwordx4 v[180:183], v1, s[32:35], s45 offen offset:128 nt
  s_waitcnt vmcnt(4)
  buffer_load_dwordx4 v[184:187], v1, s[32:35], s45 offen offset:256 nt
  s_waitcnt vmcnt(4)
  s_and_b32 s50, s50, 31
  s_mul_i32 s45, s50, 49152
  s_add_u32 s50, s50, 1
  buffer_load_dwordx4 v[188:191], v1, s[32:35], s45 offen offset:0 nt
  s_waitcnt vmcnt(4)
  buffer_load_dwordx4 v[192:195], v1, s[32:35], s45 offen offset:128 nt
  s_waitcnt vmcnt(4)
  buffer_load_dwordx4 v[196:199], v1, s[32:35], s45 offen offset:256 nt
  s_waitcnt vmcnt(4)
  s_and_b32 s50, s50, 31
  s_mul_i32 s45, s50, 49152
  s_add_u32 s50, s50, 1
  buffer_load_dwordx4 v[200:203], v1, s[32:35], s45 offen offset:0 nt
  s_waitcnt vmcnt(4)
  buffer_load_dwordx4 v[204:207], v1, s[32:35], s45 offen offset:128 nt
  s_waitcnt vmcnt(4)
  buffer_load_dwordx4 v[208:211], v1, s[32:35], s45 offen offset:256 nt
  s_waitcnt vmcnt(4)
  s_and_b32 s50, s50, 31
  s_mul_i32 s45, s50, 49152
  s_add_u32 s50, s50, 1
  buffer_load_dwordx4 v[212:215], v1, s[32:35], s45 offen offset:0 nt
  s_waitcnt vmcnt(4)
  buffer_load_dwordx4 v[216:219], v1, s[32:35], s45 offen offset:128 nt
  s_waitcnt vmcnt(4)
  buffer_load_dwordx4 v[220:223], v1, s[32:35], s45 offen offset:256 nt
  s_waitcnt vmcnt(4)
  s_and_b32 s50, s50, 31
  s_mul_i32 s45, s50, 49152
  s_add_u32 s50, s50, 1
  buffer_load_dwordx4 v[224:227], v1, s[32:35], s45 offen offset:0 nt
  s_waitcnt vmcnt(4)
  buffer_load_dwordx4 v[228:231], v1, s[32:35], s45 offen offset:128 nt
  s_waitcnt vmcnt(4)
  buffer_load_dwordx4 v[232:235], v1, s[32:35], s45 offen offset:256 nt
  s_waitcnt vmcnt(4)
  s_and_b32 s50, s50, 31
  s_mul_i32 s45, s50, 49152
  s_add_u32 s50, s50, 1
  buffer_load_dwordx4 v[236:239], v1, s[32:35], s45 offen offset:0 nt
  s_waitcnt vmcnt(4)
  buffer_load_dwordx4 v[240:243], v1, s[32:35], s45 offen offset:128 nt
  s_waitcnt vmcnt(4)
  buffer_load_dwordx4 v[244:247], v1, s[32:35], s45 offen offset:256 nt
  s_mov_b32 s62, 5747126
L_lw_1:
  ds_read_b32 v40, v248 offset:10764
  s_waitcnt lgkmcnt(0)
  v_readfirstlane_b32 s63, v40
  s_cmp_ge_u32 s63, 1
  s_cbranch_scc1 L_lok_2
  s_sleep 1
  s_sub_u32 s62, s62, 1
  s_cmp_lg_u32 s62, 0
  s_cbranch_scc1 L_lw_1
L_lok_2:
  ds_read_b128 v[16:19], v2 offset:9216
  ds_read_b128 v[20:23], v2 offset:9344
  ds_read_b128 v[24:27], v2 offset:9472
  s_waitcnt lgkmcnt(0)
  s_mul_i32 s30, s30, 0x19660d
  s_add_u32 s30, s30, 0x3c6ef35f
  s_mul_i32 s31, s31, 0x2c9277b5
  s_add_u32 s31, s31, 0xac564b05
  v_dot2_f32_bf16 v40, v80, v16, 0
  v_dot2_f32_bf16 v41, v84, v20, 0
  v_dot2_f32_bf16 v42, v88, v24, 0
  v_dot2_f32_bf16 v40, v81, v17, v40
  v_dot2_f32_bf16 v41, v85, v21, v41
  v_dot2_f32_bf16 v42, v89, v25, v42
  v_dot2_f32_bf16 v40, v82, v18, v40
  v_dot2_f32_bf16 v41, v86, v22, v41
  v_dot2_f32_bf16 v42, v90, v26, v42
  v_dot2_f32_bf16 v40, v83, v19, v40
  v_dot2_f32_bf16 v41, v87, v23, v41
  v_dot2_f32_bf16 v42, v91, v27, v42
  s_nop 1
  v_add_f32 v40, v40, v41
  v_add_f32 v40, v40, v42
  s_nop 1
  v_add_f32_dpp v40, v40, v40 quad_perm:[1,0,3,2] row_mask:0xf bank_mask:0xf
  s_nop 1
  v_add_f32_dpp v40, v40, v40 quad_perm:[2,3,0,1] row_mask:0xf bank_mask:0xf
  s_nop 1
  v_add_f32_dpp v40, v40, v40 row_half_mirror row_mask:0xf bank_mask:0xf
  v_cvt_pk_bf16_f32 v40, v40, v40
  v_and_b32 v40, 0xffff0000, v40
  v_mul_f32 v40, s46, v40
  v_cvt_pk_bf16_f32 v48, v40, v40
  v_and_b32 v48, 0xffff0000, v48
  v_mov_b32 v44, v48
  s_waitcnt vmcnt(4)
  s_and_b32 s50, s50, 31
  s_mul_i32 s45, s50, 49152
  s_add_u32 s50, s50, 1
  buffer_load_dwordx4 v[80:83], v1, s[32:35], s45 offen offset:0 nt
  v_dot2_f32_bf16 v40, v92, v16, 0
  v_dot2_f32_bf16 v41, v96, v20, 0
  v_dot2_f32_bf16 v42, v100, v24, 0
  v_dot2_f32_bf16 v40, v93, v17, v40
  v_dot2_f32_bf16 v41, v97, v21, v41
  v_dot2_f32_bf16 v42, v101, v25, v42
  v_dot2_f32_bf16 v40, v94, v18, v40
  v_dot2_f32_bf16 v41, v98, v22, v41
  v_dot2_f32_bf16 v42, v102, v26, v42
  v_dot2_f32_bf16 v40, v95, v19, v40
  v_dot2_f32_bf16 v41, v99, v23, v41
  v_dot2_f32_bf16 v42, v103, v27, v42
  s_nop 1
  v_add_f32 v40, v40, v41
  v_add_f32 v40, v40, v42
  s_nop 1
  v_add_f32_dpp v40, v40, v40 quad_perm:[1,0,3,2] row_mask:0xf bank_mask:0xf
  s_nop 1
  v_add_f32_dpp v40, v40, v40 quad_perm:[2,3,0,1] row_mask:0xf bank_mask:0xf
  s_nop 1
  v_add_f32_dpp v40, v40, v40 row_half_mirror row_mask:0xf bank_mask:0xf
  v_cvt_pk_bf16_f32 v40, v40, v40
  v_and_b32 v40, 0xffff0000, v40
  v_mul_f32 v40, s46, v40
  v_cvt_pk_bf16_f32 v49, v40, v40
  v_and_b32 v49, 0xffff0000, v49
  v_max_f32 v44, v44, v49
  s_waitcnt vmcnt(4)
  buffer_load_dwordx4 v[84:87], v1, s[32:35], s45 offen offset:128 nt
  v_dot2_f32_bf16 v40, v104, v16, 0
  v_dot2_f32_bf16 v41, v108, v20, 0
  v_dot2_f32_bf16 v42, v112, v24, 0
  v_dot2_f32_bf16 v40, v105, v17, v40
  v_dot2_f32_bf16 v41, v109, v21, v41
  v_dot2_f32_bf16 v42, v113, v25, v42
  v_dot2_f32_bf16 v40, v106, v18, v40
  v_dot2_f32_bf16 v41, v110, v22, v41
  v_dot2_f32_bf16 v42, v114, v26, v42
  v_dot2_f32_bf16 v40, v107, v19, v40
  v_dot2_f32_bf16 v41, v111, v23, v41
  v_dot2_f32_bf16 v42, v115, v27, v42
  s_nop 1
  v_add_f32 v40, v40, v41
  v_add_f32 v40, v40, v42
  s_nop 1
  v_add_f32_dpp v40, v40, v40 quad_perm:[1,0,3,2] row_mask:0xf bank_mask:0xf
  s_nop 1
  v_add_f32_dpp v40, v40, v40 quad_perm:[2,3,0,1] row_mask:0xf bank_mask:0xf
  s_nop 1
  v_add_f32_dpp v40, v40, v40 row_half_mirror row_mask:0xf bank_mask:0xf
  v_cvt_pk_bf16_f32 v40, v40, v40
  v_and_b32 v40, 0xffff0000, v40
  v_mul_f32 v40, s46, v40
  v_cvt_pk_bf16_f32 v50, v40, v40
  v_and_b32 v50, 0xffff0000, v50
  v_max_f32 v44, v44, v50
  s_waitcnt vmcnt(4)
  buffer_load_dwordx4 v[88:91], v1, s[32:35], s45 offen offset:256 nt
  v_dot2_f32_bf16 v40, v116, v16, 0
  v_dot2_f32_bf16 v41, v120, v20, 0
  v_dot2_f32_bf16 v42, v124, v24, 0
  v_dot2_f32_bf16 v40, v117, v17, v40
  v_dot2_f32_bf16 v41, v121, v21, v41
  v_dot2_f32_bf16 v42, v125, v25, v42
  v_dot2_f32_bf16 v40, v118, v18, v40
  v_dot2_f32_bf16 v41, v122, v22, v41
  v_dot2_f32_bf16 v42, v126, v26, v42
  v_dot2_f32_bf16 v40, v119, v19, v40
  v_dot2_f32_bf16 v41, v123, v23, v41
  v_dot2_f32_bf16 v42, v127, v27, v42
  s_nop 1
  v_add_f32 v40, v40, v41
  v_add_f32 v40, v40, v42
  s_nop 1
  v_add_f32_dpp v40, v40, v40 quad_perm:[1,0,3,2] row_mask:0xf bank_mask:0xf
  s_nop 1
  v_add_f32_dpp v40, v40, v40 quad_perm:[2,3,0,1] row_mask:0xf bank_mask:0xf
  s_nop 1
  v_add_f32_dpp v40, v40, v40 row_half_mirror row_mask:0xf bank_mask:0xf
  v_cvt_pk_bf16_f32 v40, v40, v40
  v_and_b32 v40, 0xffff0000, v40
  v_mul_f32 v40, s46, v40
  v_cvt_pk_bf16_f32 v51, v40, v40
  v_and_b32 v51, 0xffff0000, v51
  v_max_f32 v44, v44, v51
  s_waitcnt vmcnt(4)
  s_and_b32 s50, s50, 31
  s_mul_i32 s45, s50, 49152
  s_add_u32 s50, s50, 1
  buffer_load_dwordx4 v[92:95], v1, s[32:35], s45 offen offset:0 nt
  v_dot2_f32_bf16 v40, v128, v16, 0
  v_dot2_f32_bf16 v41, v132, v20, 0
  v_dot2_f32_bf16 v42, v136, v24, 0
  v_dot2_f32_bf16 v40, v129, v17, v40
  v_dot2_f32_bf16 v41, v133, v21, v41
  v_dot2_f32_bf16 v42, v137, v25, v42
  v_dot2_f32_bf16 v40, v130, v18, v40
  v_dot2_f32_bf16 v41, v134, v22, v41
  v_dot2_f32_bf16 v42, v138, v26, v42
  v_dot2_f32_bf16 v40, v131, v19, v40
  v_dot2_f32_bf16 v41, v135, v23, v41
  v_dot2_f32_bf16 v42, v139, v27, v42
  s_nop 1
  v_add_f32 v40, v40, v41
  v_add_f32 v40, v40, v42
  s_nop 1
  v_add_f32_dpp v40, v40, v40 quad_perm:[1,0,3,2] row_mask:0xf bank_mask:0xf
  s_nop 1
  v_add_f32_dpp v40, v40, v40 quad_perm:[2,3,0,1] row_mask:0xf bank_mask:0xf
  s_nop 1
  v_add_f32_dpp v40, v40, v40 row_half_mirror row_mask:0xf bank_mask:0xf
  v_cvt_pk_bf16_f32 v40, v40, v40
  v_and_b32 v40, 0xffff0000, v40
  v_mul_f32 v40, s46, v40
  v_cvt_pk_bf16_f32 v52, v40, v40
  v_and_b32 v52, 0xffff0000, v52
  v_max_f32 v44, v44, v52
  s_waitcnt vmcnt(4)
  buffer_load_dwordx4 v[96:99], v1, s[32:35], s45 offen offset:128 nt
  v_dot2_f32_bf16 v40, v140, v16, 0
  v_dot2_f32_bf16 v41, v144, v20, 0
  v_dot2_f32_bf16 v42, v148, v24, 0
  v_dot2_f32_bf16 v40, v141, v17, v40
  v_dot2_f32_bf16 v41, v145, v21, v41
  v_dot2_f32_bf16 v42, v149, v25, v42
  v_dot2_f32_bf16 v40, v142, v18, v40
  v_dot2_f32_bf16 v41, v146, v22, v41
  v_dot2_f32_bf16 v42, v150, v26, v42
  v_dot2_f32_bf16 v40, v143, v19, v40
  v_dot2_f32_bf16 v41, v147, v23, v41
  v_dot2_f32_bf16 v42, v151, v27, v42
  s_nop 1
  v_add_f32 v40, v40, v41
  v_add_f32 v40, v40, v42
  s_nop 1
  v_add_f32_dpp v40, v40, v40 quad_perm:[1,0,3,2] row_mask:0xf bank_mask:0xf
  s_nop 1
  v_add_f32_dpp v40, v40, v40 quad_perm:[2,3,0,1] row_mask:0xf bank_mask:0xf
  s_nop 1
  v_add_f32_dpp v40, v40, v40 row_half_mirror row_mask:0xf bank_mask:0xf
  v_cvt_pk_bf16_f32 v40, v40, v40
  v_and_b32 v40, 0xffff0000, v40
  v_mul_f32 v40, s46, v40
  v_cvt_pk_bf16_f32 v53, v40, v40
  v_and_b32 v53, 0xffff0000, v53
  v_max_f32 v44, v44, v53
  s_waitcnt vmcnt(4)
  buffer_load_dwordx4 v[100:103], v1, s[32:35], s45 offen offset:256 nt
  v_dot2_f32_bf16 v40, v152, v16, 0
  v_dot2_f32_bf16 v41, v156, v20, 0
  v_dot2_f32_bf16 v42, v160, v24, 0
  v_dot2_f32_bf16 v40, v153, v17, v40
  v_dot2_f32_bf16 v41, v157, v21, v41
  v_dot2_f32_bf16 v42, v161, v25, v42
  v_dot2_f32_bf16 v40, v154, v18, v40
  v_dot2_f32_bf16 v41, v158, v22, v41
  v_dot2_f32_bf16 v42, v162, v26, v42
  v_dot2_f32_bf16 v40, v155, v19, v40
  v_dot2_f32_bf16 v41, v159, v23, v41
  v_dot2_f32_bf16 v42, v163, v27, v42
  s_nop 1
  v_add_f32 v40, v40, v41
  v_add_f32 v40, v40, v42
  s_nop 1
  v_add_f32_dpp v40, v40, v40 quad_perm:[1,0,3,2] row_mask:0xf bank_mask:0xf
  s_nop 1
  v_add_f32_dpp v40, v40, v40 quad_perm:[2,3,0,1] row_mask:0xf bank_mask:0xf
  s_nop 1
  v_add_f32_dpp v40, v40, v40 row_half_mirror row_mask:0xf bank_mask:0xf
  v_cvt_pk_bf16_f32 v40, v40, v40
  v_and_b32 v40, 0xffff0000, v40
  v_mul_f32 v40, s46, v40
  v_cvt_pk_bf16_f32 v54, v40, v40
  v_and_b32 v54, 0xffff0000, v54
  v_max_f32 v44, v44, v54
  s_waitcnt vmcnt(4)
  s_and_b32 s50, s50, 31
  s_mul_i32 s45, s50, 49152
  s_add_u32 s50, s50, 1
  buffer_load_dwordx4 v[104:107], v1, s[32:35], s45 offen offset:0 nt
  v_dot2_f32_bf16 v40, v164, v16, 0
  v_dot2_f32_bf16 v41, v168, v20, 0
  v_dot2_f32_bf16 v42, v172, v24, 0
  v_dot2_f32_bf16 v40, v165, v17, v40
  v_dot2_f32_bf16 v41, v169, v21, v41
  v_dot2_f32_bf16 v42, v173, v25, v42
  v_dot2_f32_bf16 v40, v166, v18, v40
  v_dot2_f32_bf16 v41, v170, v22, v41
  v_dot2_f32_bf16 v42, v174, v26, v42
  v_dot2_f32_bf16 v40, v167, v19, v40
  v_dot2_f32_bf16 v41, v171, v23, v41
  v_dot2_f32_bf16 v42, v175, v27, v42
  s_nop 1
  v_add_f32 v40, v40, v41
  v_add_f32 v40, v40, v42
  s_nop 1
  v_add_f32_dpp v40, v40, v40 quad_perm:[1,0,3,2] row_mask:0xf bank_mask:0xf
  s_nop 1
  v_add_f32_dpp v40, v40, v40 quad_perm:[2,3,0,1] row_mask:0xf bank_mask:0xf
  s_nop 1
  v_add_f32_dpp v40, v40, v40 row_half_mirror row_mask:0xf bank_mask:0xf
  v_cvt_pk_bf16_f32 v40, v40, v40
  v_and_b32 v40, 0xffff0000, v40
  v_mul_f32 v40, s46, v40
  v_cvt_pk_bf16_f32 v55, v40, v40
  v_and_b32 v55, 0xffff0000, v55
  v_max_f32 v44, v44, v55
  s_waitcnt vmcnt(4)
  buffer_load_dwordx4 v[108:111], v1, s[32:35], s45 offen offset:128 nt
  v_dot2_f32_bf16 v40, v176, v16, 0
  v_dot2_f32_bf16 v41, v180, v20, 0
  v_dot2_f32_bf16 v42, v184, v24, 0
  v_dot2_f32_bf16 v40, v177, v17, v40
  v_dot2_f32_bf16 v41, v181, v21, v41
  v_dot2_f32_bf16 v42, v185, v25, v42
  v_dot2_f32_bf16 v40, v178, v18, v40
  v_dot2_f32_bf16 v41, v182, v22, v41
  v_dot2_f32_bf16 v42, v186, v26, v42
  v_dot2_f32_bf16 v40, v179, v19, v40
  v_dot2_f32_bf16 v41, v183, v23, v41
  v_dot2_f32_bf16 v42, v187, v27, v42
  s_nop 1
  v_add_f32 v40, v40, v41
  v_add_f32 v40, v40, v42
  s_nop 1
  v_add_f32_dpp v40, v40, v40 quad_perm:[1,0,3,2] row_mask:0xf bank_mask:0xf
  s_nop 1
  v_add_f32_dpp v40, v40, v40 quad_perm:[2,3,0,1] row_mask:0xf bank_mask:0xf
  s_nop 1
  v_add_f32_dpp v40, v40, v40 row_half_mirror row_mask:0xf bank_mask:0xf
  v_cvt_pk_bf16_f32 v40, v40, v40
  v_and_b32 v40, 0xffff0000, v40
  v_mul_f32 v40, s46, v40
  v_cvt_pk_bf16_f32 v56, v40, v40
  v_and_b32 v56, 0xffff0000, v56
  v_max_f32 v44, v44, v56
  s_waitcnt vmcnt(4)
  buffer_load_dwordx4 v[112:115], v1, s[32:35], s45 offen offset:256 nt
  v_dot2_f32_bf16 v40, v188, v16, 0
  v_dot2_f32_bf16 v41, v192, v20, 0
  v_dot2_f32_bf16 v42, v196, v24, 0
  v_dot2_f32_bf16 v40, v189, v17, v40
  v_dot2_f32_bf16 v41, v193, v21, v41
  v_dot2_f32_bf16 v42, v197, v25, v42
  v_dot2_f32_bf16 v40, v190, v18, v40
  v_dot2_f32_bf16 v41, v194, v22, v41
  v_dot2_f32_bf16 v42, v198, v26, v42
  v_dot2_f32_bf16 v40, v191, v19, v40
  v_dot2_f32_bf16 v41, v195, v23, v41
  v_dot2_f32_bf16 v42, v199, v27, v42
  s_nop 1
  v_add_f32 v40, v40, v41
  v_add_f32 v40, v40, v42
  s_nop 1
  v_add_f32_dpp v40, v40, v40 quad_perm:[1,0,3,2] row_mask:0xf bank_mask:0xf
  s_nop 1
  v_add_f32_dpp v40, v40, v40 quad_perm:[2,3,0,1] row_mask:0xf bank_mask:0xf
  s_nop 1
  v_add_f32_dpp v40, v40, v40 row_half_mirror row_mask:0xf bank_mask:0xf
  v_cvt_pk_bf16_f32 v40, v40, v40
  v_and_b32 v40, 0xffff0000, v40
  v_mul_f32 v40, s46, v40
  v_cvt_pk_bf16_f32 v57, v40, v40
  v_and_b32 v57, 0xffff0000, v57
  v_max_f32 v44, v44, v57
  s_waitcnt vmcnt(4)
  s_and_b32 s50, s50, 31
  s_mul_i32 s45, s50, 49152
  s_add_u32 s50, s50, 1
  buffer_load_dwordx4 v[116:119], v1, s[32:35], s45 offen offset:0 nt
  v_dot2_f32_bf16 v40, v200, v16, 0
  v_dot2_f32_bf16 v41, v204, v20, 0
  v_dot2_f32_bf16 v42, v208, v24, 0
  v_dot2_f32_bf16 v40, v201, v17, v40
  v_dot2_f32_bf16 v41, v205, v21, v41
  v_dot2_f32_bf16 v42, v209, v25, v42
  v_dot2_f32_bf16 v40, v202, v18, v40
  v_dot2_f32_bf16 v41, v206, v22, v41
  v_dot2_f32_bf16 v42, v210, v26, v42
  v_dot2_f32_bf16 v40, v203, v19, v40
  v_dot2_f32_bf16 v41, v207, v23, v41
  v_dot2_f32_bf16 v42, v211, v27, v42
  s_nop 1
  v_add_f32 v40, v40, v41
  v_add_f32 v40, v40, v42
  s_nop 1
  v_add_f32_dpp v40, v40, v40 quad_perm:[1,0,3,2] row_mask:0xf bank_mask:0xf
  s_nop 1
  v_add_f32_dpp v40, v40, v40 quad_perm:[2,3,0,1] row_mask:0xf bank_mask:0xf
  s_nop 1
  v_add_f32_dpp v40, v40, v40 row_half_mirror row_mask:0xf bank_mask:0xf
  v_cvt_pk_bf16_f32 v40, v40, v40
  v_and_b32 v40, 0xffff0000, v40
  v_mul_f32 v40, s46, v40
  v_cvt_pk_bf16_f32 v58, v40, v40
  v_and_b32 v58, 0xffff0000, v58
  v_max_f32 v44, v44, v58
  s_waitcnt vmcnt(4)
  buffer_load_dwordx4 v[120:123], v1, s[32:35], s45 offen offset:128 nt
  v_dot2_f32_bf16 v40, v212, v16, 0
  v_dot2_f32_bf16 v41, v216, v20, 0
  v_dot2_f32_bf16 v42, v220, v24, 0
  v_dot2_f32_bf16 v40, v213, v17, v40
  v_dot2_f32_bf16 v41, v217, v21, v41
  v_dot2_f32_bf16 v42, v221, v25, v42
  v_dot2_f32_bf16 v40, v214, v18, v40
  v_dot2_f32_bf16 v41, v218, v22, v41
  v_dot2_f32_bf16 v42, v222, v26, v42
  v_dot2_f32_bf16 v40, v215, v19, v40
  v_dot2_f32_bf16 v41, v219, v23, v41
  v_dot2_f32_bf16 v42, v223, v27, v42
  s_nop 1
  v_add_f32 v40, v40, v41
  v_add_f32 v40, v40, v42
  s_nop 1
  v_add_f32_dpp v40, v40, v40 quad_perm:[1,0,3,2] row_mask:0xf bank_mask:0xf
  s_nop 1
  v_add_f32_dpp v40, v40, v40 quad_perm:[2,3,0,1] row_mask:0xf bank_mask:0xf
  s_nop 1
  v_add_f32_dpp v40, v40, v40 row_half_mirror row_mask:0xf bank_mask:0xf
  v_cvt_pk_bf16_f32 v40, v40, v40
  v_and_b32 v40, 0xffff0000, v40
  v_mul_f32 v40, s46, v40
  v_cvt_pk_bf16_f32 v59, v40, v40
  v_and_b32 v59, 0xffff0000, v59
  v_max_f32 v44, v44, v59
  s_waitcnt vmcnt(4)
  buffer_load_dwordx4 v[124:127], v1, s[32:35], s45 offen offset:256 nt
  v_dot2_f32_bf16 v40, v224, v16, 0
  v_dot2_f32_bf16 v41, v228, v20, 0
  v_dot2_f32_bf16 v42, v232, v24, 0
  v_dot2_f32_bf16 v40, v225, v17, v40
  v_dot2_f32_bf16 v41, v229, v21, v41
  v_dot2_f32_bf16 v42, v233, v25, v42
  v_dot2_f32_bf16 v40, v226, v18, v40
  v_dot2_f32_bf16 v41, v230, v22, v41
  v_dot2_f32_bf16 v42, v234, v26, v42
  v_dot2_f32_bf16 v40, v227, v19, v40
  v_dot2_f32_bf16 v41, v231, v23, v41
  v_dot2_f32_bf16 v42, v235, v27, v42
  s_nop 1
  v_add_f32 v40, v40, v41
  v_add_f32 v40, v40, v42
  s_nop 1
  v_add_f32_dpp v40, v40, v40 quad_perm:[1,0,3,2] row_mask:0xf bank_mask:0xf
  s_nop 1
  v_add_f32_dpp v40, v40, v40 quad_perm:[2,3,0,1] row_mask:0xf bank_mask:0xf
  s_nop 1
  v_add_f32_dpp v40, v40, v40 row_half_mirror row_mask:0xf bank_mask:0xf
  v_cvt_pk_bf16_f32 v40, v40, v40
  v_and_b32 v40, 0xffff0000, v40
  v_mul_f32 v40, s46, v40
  v_cvt_pk_bf16_f32 v60, v40, v40
  v_and_b32 v60, 0xffff0000, v60
  v_max_f32 v44, v44, v60
  s_waitcnt vmcnt(4)
  s_and_b32 s50, s50, 31
  s_mul_i32 s45, s50, 49152
  s_add_u32 s50, s50, 1
  buffer_load_dwordx4 v[128:131], v1, s[32:35], s45 offen offset:0 nt
  v_dot2_f32_bf16 v40, v236, v16, 0
  v_dot2_f32_bf16 v41, v240, v20, 0
  v_dot2_f32_bf16 v42, v244, v24, 0
  v_dot2_f32_bf16 v40, v237, v17, v40
  v_dot2_f32_bf16 v41, v241, v21, v41
  v_dot2_f32_bf16 v42, v245, v25, v42
  v_dot2_f32_bf16 v40, v238, v18, v40
  v_dot2_f32_bf16 v41, v242, v22, v41
  v_dot2_f32_bf16 v42, v246, v26, v42
  v_dot2_f32_bf16 v40, v239, v19, v40
  v_dot2_f32_bf16 v41, v243, v23, v41
  v_dot2_f32_bf16 v42, v247, v27, v42
  s_nop 1
  v_add_f32 v40, v40, v41
  v_add_f32 v40, v40, v42
  s_nop 1
  v_add_f32_dpp v40, v40, v40 quad_perm:[1,0,3,2] row_mask:0xf bank_mask:0xf
  s_nop 1
  v_add_f32_dpp v40, v40, v40 quad_perm:[2,3,0,1] row_mask:0xf bank_mask:0xf
  s_nop 1
  v_add_f32_dpp v40, v40, v40 row_half_mirror row_mask:0xf bank_mask:0xf
  v_cvt_pk_bf16_f32 v40, v40, v40
  v_and_b32 v40, 0xffff0000, v40
  v_mul_f32 v40, s46, v40
  v_cvt_pk_bf16_f32 v61, v40, v40
  v_and_b32 v61, 0xffff0000, v61
  v_max_f32 v44, v44, v61
  s_waitcnt vmcnt(4)
  buffer_load_dwordx4 v[132:135], v1, s[32:35], s45 offen offset:128 nt
  v_dot2_f32_bf16 v40, v80, v16, 0
  v_dot2_f32_bf16 v41, v84, v20, 0
  v_dot2_f32_bf16 v42, v88, v24, 0
  v_dot2_f32_bf16 v40, v81, v17, v40
  v_dot2_f32_bf16 v41, v85, v21, v41
  v_dot2_f32_bf16 v42, v89, v25, v42
  v_dot2_f32_bf16 v40, v82, v18, v40
  v_dot2_f32_bf16 v41, v86, v22, v41
  v_dot2_f32_bf16 v42, v90, v26, v42
  v_dot2_f32_bf16 v40, v83, v19, v40
  v_dot2_f32_bf16 v41, v87, v23, v41
  v_dot2_f32_bf16 v42, v91, v27, v42
  s_nop 1
  v_add_f32 v40, v40, v41
  v_add_f32 v40, v40, v42
  s_nop 1
  v_add_f32_dpp v40, v40, v40 quad_perm:[1,0,3,2] row_mask:0xf bank_mask:0xf
  s_nop 1
  v_add_f32_dpp v40, v40, v40 quad_perm:[2,3,0,1] row_mask:0xf bank_mask:0xf
  s_nop 1
  v_add_f32_dpp v40, v40, v40 row_half_mirror row_mask:0xf bank_mask:0xf
  v_cvt_pk_bf16_f32 v40, v40, v40
  v_and_b32 v40, 0xffff0000, v40
  v_mul_f32 v40, s46, v40
  v_cvt_pk_bf16_f32 v62, v40, v40
  v_and_b32 v62, 0xffff0000, v62
  v_max_f32 v44, v44, v62
  s_waitcnt vmcnt(4)
  buffer_load_dwordx4 v[136:139], v1, s[32:35], s45 offen offset:256 nt
  v_dot2_f32_bf16 v40, v92, v16, 0
  v_dot2_f32_bf16 v41, v96, v20, 0
  v_dot2_f32_bf16 v42, v100, v24, 0
  v_dot2_f32_bf16 v40, v93, v17, v40
  v_dot2_f32_bf16 v41, v97, v21, v41
  v_dot2_f32_bf16 v42, v101, v25, v42
  v_dot2_f32_bf16 v40, v94, v18, v40
  v_dot2_f32_bf16 v41, v98, v22, v41
  v_dot2_f32_bf16 v42, v102, v26, v42
  v_dot2_f32_bf16 v40, v95, v19, v40
  v_dot2_f32_bf16 v41, v99, v23, v41
  v_dot2_f32_bf16 v42, v103, v27, v42
  s_nop 1
  v_add_f32 v40, v40, v41
  v_add_f32 v40, v40, v42
  s_nop 1
  v_add_f32_dpp v40, v40, v40 quad_perm:[1,0,3,2] row_mask:0xf bank_mask:0xf
  s_nop 1
  v_add_f32_dpp v40, v40, v40 quad_perm:[2,3,0,1] row_mask:0xf bank_mask:0xf
  s_nop 1
  v_add_f32_dpp v40, v40, v40 row_half_mirror row_mask:0xf bank_mask:0xf
  v_cvt_pk_bf16_f32 v40, v40, v40
  v_and_b32 v40, 0xffff0000, v40
  v_mul_f32 v40, s46, v40
  v_cvt_pk_bf16_f32 v63, v40, v40
  v_and_b32 v63, 0xffff0000, v63
  v_max_f32 v44, v44, v63
  s_waitcnt vmcnt(4)
  s_and_b32 s50, s50, 31
  s_mul_i32 s45, s50, 49152
  s_add_u32 s50, s50, 1
  buffer_load_dwordx4 v[140:143], v1, s[32:35], s45 offen offset:0 nt
  v_dot2_f32_bf16 v40, v104, v16, 0
  v_dot2_f32_bf16 v41, v108, v20, 0
  v_dot2_f32_bf16 v42, v112, v24, 0
  v_dot2_f32_bf16 v40, v105, v17, v40
  v_dot2_f32_bf16 v41, v109, v21, v41
  v_dot2_f32_bf16 v42, v113, v25, v42
  v_dot2_f32_bf16 v40, v106, v18, v40
  v_dot2_f32_bf16 v41, v110, v22, v41
  v_dot2_f32_bf16 v42, v114, v26, v42
  v_dot2_f32_bf16 v40, v107, v19, v40
  v_dot2_f32_bf16 v41, v111, v23, v41
  v_dot2_f32_bf16 v42, v115, v27, v42
  s_nop 1
  v_add_f32 v40, v40, v41
  v_add_f32 v40, v40, v42
  s_nop 1
  v_add_f32_dpp v40, v40, v40 quad_perm:[1,0,3,2] row_mask:0xf bank_mask:0xf
  s_nop 1
  v_add_f32_dpp v40, v40, v40 quad_perm:[2,3,0,1] row_mask:0xf bank_mask:0xf
  s_nop 1
  v_add_f32_dpp v40, v40, v40 row_half_mirror row_mask:0xf bank_mask:0xf
  v_cvt_pk_bf16_f32 v40, v40, v40
  v_and_b32 v40, 0xffff0000, v40
  v_mul_f32 v40, s46, v40
  v_cvt_pk_bf16_f32 v64, v40, v40
  v_and_b32 v64, 0xffff0000, v64
  v_max_f32 v44, v44, v64
  s_waitcnt vmcnt(4)
  buffer_load_dwordx4 v[144:147], v1, s[32:35], s45 offen offset:128 nt
  v_dot2_f32_bf16 v40, v116, v16, 0
  v_dot2_f32_bf16 v41, v120, v20, 0
  v_dot2_f32_bf16 v42, v124, v24, 0
  v_dot2_f32_bf16 v40, v117, v17, v40
  v_dot2_f32_bf16 v41, v121, v21, v41
  v_dot2_f32_bf16 v42, v125, v25, v42
  v_dot2_f32_bf16 v40, v118, v18, v40
  v_dot2_f32_bf16 v41, v122, v22, v41
  v_dot2_f32_bf16 v42, v126, v26, v42
  v_dot2_f32_bf16 v40, v119, v19, v40
  v_dot2_f32_bf16 v41, v123, v23, v41
  v_dot2_f32_bf16 v42, v127, v27, v42
  s_nop 1
  v_add_f32 v40, v40, v41
  v_add_f32 v40, v40, v42
  s_nop 1
  v_add_f32_dpp v40, v40, v40 quad_perm:[1,0,3,2] row_mask:0xf bank_mask:0xf
  s_nop 1
  v_add_f32_dpp v40, v40, v40 quad_perm:[2,3,0,1] row_mask:0xf bank_mask:0xf
  s_nop 1
  v_add_f32_dpp v40, v40, v40 row_half_mirror row_mask:0xf bank_mask:0xf
  v_cvt_pk_bf16_f32 v40, v40, v40
  v_and_b32 v40, 0xffff0000, v40
  v_mul_f32 v40, s46, v40
  v_cvt_pk_bf16_f32 v65, v40, v40
  v_and_b32 v65, 0xffff0000, v65
  v_max_f32 v44, v44, v65
  s_waitcnt vmcnt(4)
  buffer_load_dwordx4 v[148:151], v1, s[32:35], s45 offen offset:256 nt
  s_waitcnt vmcnt(4)
  s_and_b32 s50, s50, 31
  s_mul_i32 s45, s50, 49152
  s_add_u32 s50, s50, 1
  buffer_load_dwordx4 v[152:155], v1, s[32:35], s45 offen offset:0 nt
  s_waitcnt vmcnt(4)
  buffer_load_dwordx4 v[156:159], v1, s[32:35], s45 offen offset:128 nt
  v_dot2_f32_bf16 v40, v128, v16, 0
  v_dot2_f32_bf16 v41, v132, v20, 0
  v_dot2_f32_bf16 v42, v136, v24, 0
  v_dot2_f32_bf16 v40, v129, v17, v40
  v_dot2_f32_bf16 v41, v133, v21, v41
  v_dot2_f32_bf16 v42, v137, v25, v42
  v_dot2_f32_bf16 v40, v130, v18, v40
  v_dot2_f32_bf16 v41, v134, v22, v41
  v_dot2_f32_bf16 v42, v138, v26, v42
  v_dot2_f32_bf16 v40, v131, v19, v40
  v_dot2_f32_bf16 v41, v135, v23, v41
  v_dot2_f32_bf16 v42, v139, v27, v42
  s_nop 1
  v_add_f32 v40, v40, v41
  v_add_f32 v40, v40, v42
  s_nop 1
  v_add_f32_dpp v40, v40, v40 quad_perm:[1,0,3,2] row_mask:0xf bank_mask:0xf
  s_nop 1
  v_add_f32_dpp v40, v40, v40 quad_perm:[2,3,0,1] row_mask:0xf bank_mask:0xf
  s_nop 1
  v_add_f32_dpp v40, v40, v40 row_half_mirror row_mask:0xf bank_mask:0xf
  v_cvt_pk_bf16_f32 v40, v40, v40
  v_and_b32 v40, 0xffff0000, v40
  v_mul_f32 v40, s46, v40
  v_cvt_pk_bf16_f32 v66, v40, v40
  v_and_b32 v66, 0xffff0000, v66
  v_max_f32 v44, v44, v66
  s_waitcnt vmcnt(4)
  buffer_load_dwordx4 v[160:163], v1, s[32:35], s45 offen offset:256 nt
  s_waitcnt vmcnt(4)
  s_and_b32 s50, s50, 31
  s_mul_i32 s45, s50, 49152
  s_add_u32 s50, s50, 1
  buffer_load_dwordx4 v[164:167], v1, s[32:35], s45 offen offset:0 nt
  s_waitcnt vmcnt(4)
  buffer_load_dwordx4 v[168:171], v1, s[32:35], s45 offen offset:128 nt
  v_dot2_f32_bf16 v40, v140, v16, 0
  v_dot2_f32_bf16 v41, v144, v20, 0
  v_dot2_f32_bf16 v42, v148, v24, 0
  v_dot2_f32_bf16 v40, v141, v17, v40
  v_dot2_f32_bf16 v41, v145, v21, v41
  v_dot2_f32_bf16 v42, v149, v25, v42
  v_dot2_f32_bf16 v40, v142, v18, v40
  v_dot2_f32_bf16 v41, v146, v22, v41
  v_dot2_f32_bf16 v42, v150, v26, v42
  v_dot2_f32_bf16 v40, v143, v19, v40
  v_dot2_f32_bf16 v41, v147, v23, v41
  v_dot2_f32_bf16 v42, v151, v27, v42
  s_nop 1
  v_add_f32 v40, v40, v41
  v_add_f32 v40, v40, v42
  s_nop 1
  v_add_f32_dpp v40, v40, v40 quad_perm:[1,0,3,2] row_mask:0xf bank_mask:0xf
  s_nop 1
  v_add_f32_dpp v40, v40, v40 quad_perm:[2,3,0,1] row_mask:0xf bank_mask:0xf
  s_nop 1
  v_add_f32_dpp v40, v40, v40 row_half_mirror row_mask:0xf bank_mask:0xf
  v_cvt_pk_bf16_f32 v40, v40, v40
  v_and_b32 v40, 0xffff0000, v40
  v_mul_f32 v40, s46, v40
  v_cvt_pk_bf16_f32 v67, v40, v40
  v_and_b32 v67, 0xffff0000, v67
  v_max_f32 v44, v44, v67
  s_waitcnt vmcnt(4)
  buffer_load_dwordx4 v[172:175], v1, s[32:35], s45 offen offset:256 nt
  s_waitcnt vmcnt(4)
  s_and_b32 s50, s50, 31
  s_mul_i32 s45, s50, 49152
  s_add_u32 s50, s50, 1
  buffer_load_dwordx4 v[176:179], v1, s[32:35], s45 offen offset:0 nt
  s_waitcnt vmcnt(4)
  buffer_load_dwordx4 v[180:183], v1, s[32:35], s45 offen offset:128 nt
  v_dot2_f32_bf16 v40, v152, v16, 0
  v_dot2_f32_bf16 v41, v156, v20, 0
  v_dot2_f32_bf16 v42, v160, v24, 0
  v_dot2_f32_bf16 v40, v153, v17, v40
  v_dot2_f32_bf16 v41, v157, v21, v41
  v_dot2_f32_bf16 v42, v161, v25, v42
  v_dot2_f32_bf16 v40, v154, v18, v40
  v_dot2_f32_bf16 v41, v158, v22, v41
  v_dot2_f32_bf16 v42, v162, v26, v42
  v_dot2_f32_bf16 v40, v155, v19, v40
  v_dot2_f32_bf16 v41, v159, v23, v41
  v_dot2_f32_bf16 v42, v163, v27, v42
  s_nop 1
  v_add_f32 v40, v40, v41
  v_add_f32 v40, v40, v42
  s_nop 1
  v_add_f32_dpp v40, v40, v40 quad_perm:[1,0,3,2] row_mask:0xf bank_mask:0xf
  s_nop 1
  v_add_f32_dpp v40, v40, v40 quad_perm:[2,3,0,1] row_mask:0xf bank_mask:0xf
  s_nop 1
  v_add_f32_dpp v40, v40, v40 row_half_mirror row_mask:0xf bank_mask:0xf
  v_cvt_pk_bf16_f32 v40, v40, v40
  v_and_b32 v40, 0xffff0000, v40
  v_mul_f32 v40, s46, v40
  v_cvt_pk_bf16_f32 v68, v40, v40
  v_and_b32 v68, 0xffff0000, v68
  v_max_f32 v44, v44, v68
  s_waitcnt vmcnt(4)
  buffer_load_dwordx4 v[184:187], v1, s[32:35], s45 offen offset:256 nt
  s_waitcnt vmcnt(4)
  s_and_b32 s50, s50, 31
  s_mul_i32 s45, s50, 49152
  s_add_u32 s50, s50, 1
  buffer_load_dwordx4 v[188:191], v1, s[32:35], s45 offen offset:0 nt
  s_waitcnt vmcnt(4)
  buffer_load_dwordx4 v[192:195], v1, s[32:35], s45 offen offset:128 nt
  v_dot2_f32_bf16 v40, v164, v16, 0
  v_dot2_f32_bf16 v41, v168, v20, 0
  v_dot2_f32_bf16 v42, v172, v24, 0
  v_dot2_f32_bf16 v40, v165, v17, v40
  v_dot2_f32_bf16 v41, v169, v21, v41
  v_dot2_f32_bf16 v42, v173, v25, v42
  v_dot2_f32_bf16 v40, v166, v18, v40
  v_dot2_f32_bf16 v41, v170, v22, v41
  v_dot2_f32_bf16 v42, v174, v26, v42
  v_dot2_f32_bf16 v40, v167, v19, v40
  v_dot2_f32_bf16 v41, v171, v23, v41
  v_dot2_f32_bf16 v42, v175, v27, v42
  s_nop 1
  v_add_f32 v40, v40, v41
  v_add_f32 v40, v40, v42
  s_nop 1
  v_add_f32_dpp v40, v40, v40 quad_perm:[1,0,3,2] row_mask:0xf bank_mask:0xf
  s_nop 1
  v_add_f32_dpp v40, v40, v40 quad_perm:[2,3,0,1] row_mask:0xf bank_mask:0xf
  s_nop 1
  v_add_f32_dpp v40, v40, v40 row_half_mirror row_mask:0xf bank_mask:0xf
  v_cvt_pk_bf16_f32 v40, v40, v40
  v_and_b32 v40, 0xffff0000, v40
  v_mul_f32 v40, s46, v40
  v_cvt_pk_bf16_f32 v69, v40, v40
  v_and_b32 v69, 0xffff0000, v69
  v_max_f32 v44, v44, v69
  s_waitcnt vmcnt(4)
  buffer_load_dwordx4 v[196:199], v1, s[32:35], s45 offen offset:256 nt
  s_waitcnt vmcnt(4)
  s_and_b32 s50, s50, 31
  s_mul_i32 s45, s50, 49152
  s_add_u32 s50, s50, 1
  buffer_load_dwordx4 v[200:203], v1, s[32:35], s45 offen offset:0 nt
  s_waitcnt vmcnt(4)
  buffer_load_dwordx4 v[204:207], v1, s[32:35], s45 offen offset:128 nt
  v_dot2_f32_bf16 v40, v176, v16, 0
  v_dot2_f32_bf16 v41, v180, v20, 0
  v_dot2_f32_bf16 v42, v184, v24, 0
  v_dot2_f32_bf16 v40, v177, v17, v40
  v_dot2_f32_bf16 v41, v181, v21, v41
  v_dot2_f32_bf16 v42, v185, v25, v42
  v_dot2_f32_bf16 v40, v178, v18, v40
  v_dot2_f32_bf16 v41, v182, v22, v41
  v_dot2_f32_bf16 v42, v186, v26, v42
  v_dot2_f32_bf16 v40, v179, v19, v40
  v_dot2_f32_bf16 v41, v183, v23, v41
  v_dot2_f32_bf16 v42, v187, v27, v42
  s_nop 1
  v_add_f32 v40, v40, v41
  v_add_f32 v40, v40, v42
  s_nop 1
  v_add_f32_dpp v40, v40, v40 quad_perm:[1,0,3,2] row_mask:0xf bank_mask:0xf
  s_nop 1
  v_add_f32_dpp v40, v40, v40 quad_perm:[2,3,0,1] row_mask:0xf bank_mask:0xf
  s_nop 1
  v_add_f32_dpp v40, v40, v40 row_half_mirror row_mask:0xf bank_mask:0xf
  v_cvt_pk_bf16_f32 v40, v40, v40
  v_and_b32 v40, 0xffff0000, v40
  v_mul_f32 v40, s46, v40
  v_cvt_pk_bf16_f32 v70, v40, v40
  v_and_b32 v70, 0xffff0000, v70
  v_max_f32 v44, v44, v70
  s_waitcnt vmcnt(4)
  buffer_load_dwordx4 v[208:211], v1, s[32:35], s45 offen offset:256 nt
  s_waitcnt vmcnt(4)
  s_and_b32 s50, s50, 31
  s_mul_i32 s45, s50, 49152
  s_add_u32 s50, s50, 1
  buffer_load_dwordx4 v[212:215], v1, s[32:35], s45 offen offset:0 nt
  s_waitcnt vmcnt(4)
  buffer_load_dwordx4 v[216:219], v1, s[32:35], s45 offen offset:128 nt
  v_dot2_f32_bf16 v40, v188, v16, 0
  v_dot2_f32_bf16 v41, v192, v20, 0
  v_dot2_f32_bf16 v42, v196, v24, 0
  v_dot2_f32_bf16 v40, v189, v17, v40
  v_dot2_f32_bf16 v41, v193, v21, v41
  v_dot2_f32_bf16 v42, v197, v25, v42
  v_dot2_f32_bf16 v40, v190, v18, v40
  v_dot2_f32_bf16 v41, v194, v22, v41
  v_dot2_f32_bf16 v42, v198, v26, v42
  v_dot2_f32_bf16 v40, v191, v19, v40
  v_dot2_f32_bf16 v41, v195, v23, v41
  v_dot2_f32_bf16 v42, v199, v27, v42
  s_nop 1
  v_add_f32 v40, v40, v41
  v_add_f32 v40, v40, v42
  s_nop 1
  v_add_f32_dpp v40, v40, v40 quad_perm:[1,0,3,2] row_mask:0xf bank_mask:0xf
  s_nop 1
  v_add_f32_dpp v40, v40, v40 quad_perm:[2,3,0,1] row_mask:0xf bank_mask:0xf
  s_nop 1
  v_add_f32_dpp v40, v40, v40 row_half_mirror row_mask:0xf bank_mask:0xf
  v_cvt_pk_bf16_f32 v40, v40, v40
  v_and_b32 v40, 0xffff0000, v40
  v_mul_f32 v40, s46, v40
  v_cvt_pk_bf16_f32 v71, v40, v40
  v_and_b32 v71, 0xffff0000, v71
  v_max_f32 v44, v44, v71
  s_waitcnt vmcnt(4)
  buffer_load_dwordx4 v[220:223], v1, s[32:35], s45 offen offset:256 nt
  s_waitcnt vmcnt(4)
  s_and_b32 s50, s50, 31
  s_mul_i32 s45, s50, 49152
  s_add_u32 s50, s50, 1
  buffer_load_dwordx4 v[224:227], v1, s[32:35], s45 offen offset:0 nt
  s_waitcnt vmcnt(4)
  buffer_load_dwordx4 v[228:231], v1, s[32:35], s45 offen offset:128 nt
  v_dot2_f32_bf16 v40, v200, v16, 0
  v_dot2_f32_bf16 v41, v204, v20, 0
  v_dot2_f32_bf16 v42, v208, v24, 0
  v_dot2_f32_bf16 v40, v201, v17, v40
  v_dot2_f32_bf16 v41, v205, v21, v41
  v_dot2_f32_bf16 v42, v209, v25, v42
  v_dot2_f32_bf16 v40, v202, v18, v40
  v_dot2_f32_bf16 v41, v206, v22, v41
  v_dot2_f32_bf16 v42, v210, v26, v42
  v_dot2_f32_bf16 v40, v203, v19, v40
  v_dot2_f32_bf16 v41, v207, v23, v41
  v_dot2_f32_bf16 v42, v211, v27, v42
  s_nop 1
  v_add_f32 v40, v40, v41
  v_add_f32 v40, v40, v42
  s_nop 1
  v_add_f32_dpp v40, v40, v40 quad_perm:[1,0,3,2] row_mask:0xf bank_mask:0xf
  s_nop 1
  v_add_f32_dpp v40, v40, v40 quad_perm:[2,3,0,1] row_mask:0xf bank_mask:0xf
  s_nop 1
  v_add_f32_dpp v40, v40, v40 row_half_mirror row_mask:0xf bank_mask:0xf
  v_cvt_pk_bf16_f32 v40, v40, v40
  v_and_b32 v40, 0xffff0000, v40
  v_mul_f32 v40, s46, v40
  v_cvt_pk_bf16_f32 v72, v40, v40
  v_and_b32 v72, 0xffff0000, v72
  v_max_f32 v44, v44, v72
  s_waitcnt vmcnt(4)
  buffer_load_dwordx4 v[232:235], v1, s[32:35], s45 offen offset:256 nt
  s_waitcnt vmcnt(4)
  s_and_b32 s50, s50, 31
  s_mul_i32 s45, s50, 49152
  s_add_u32 s50, s50, 1
  buffer_load_dwordx4 v[236:239], v1, s[32:35], s45 offen offset:0 nt
  s_waitcnt vmcnt(4)
  buffer_load_dwordx4 v[240:243], v1, s[32:35], s45 offen offset:128 nt
  v_dot2_f32_bf16 v40, v212, v16, 0
  v_dot2_f32_bf16 v41, v216, v20, 0
  v_dot2_f32_bf16 v42, v220, v24, 0
  v_dot2_f32_bf16 v40, v213, v17, v40
  v_dot2_f32_bf16 v41, v217, v21, v41
  v_dot2_f32_bf16 v42, v221, v25, v42
  v_dot2_f32_bf16 v40, v214, v18, v40
  v_dot2_f32_bf16 v41, v218, v22, v41
  v_dot2_f32_bf16 v42, v222, v26, v42
  v_dot2_f32_bf16 v40, v215, v19, v40
  v_dot2_f32_bf16 v41, v219, v23, v41
  v_dot2_f32_bf16 v42, v223, v27, v42
  s_nop 1
  v_add_f32 v40, v40, v41
  v_add_f32 v40, v40, v42
  s_nop 1
  v_add_f32_dpp v40, v40, v40 quad_perm:[1,0,3,2] row_mask:0xf bank_mask:0xf
  s_nop 1
  v_add_f32_dpp v40, v40, v40 quad_perm:[2,3,0,1] row_mask:0xf bank_mask:0xf
  s_nop 1
  v_add_f32_dpp v40, v40, v40 row_half_mirror row_mask:0xf bank_mask:0xf
  v_cvt_pk_bf16_f32 v40, v40, v40
  v_and_b32 v40, 0xffff0000, v40
  v_mul_f32 v40, s46, v40
  v_cvt_pk_bf16_f32 v73, v40, v40
  v_and_b32 v73, 0xffff0000, v73
  v_max_f32 v44, v44, v73
  s_waitcnt vmcnt(4)
  buffer_load_dwordx4 v[244:247], v1, s[32:35], s45 offen offset:256 nt
  s_waitcnt vmcnt(4)
  s_and_b32 s50, s50, 31
  s_mul_i32 s45, s50, 49152
  s_add_u32 s50, s50, 1
  buffer_load_dwordx4 v[80:83], v1, s[32:35], s45 offen offset:0 nt
  s_waitcnt vmcnt(4)
  buffer_load_dwordx4 v[84:87], v1, s[32:35], s45 offen offset:128 nt
  v_dot2_f32_bf16 v40, v224, v16, 0
  v_dot2_f32_bf16 v41, v228, v20, 0
  v_dot2_f32_bf16 v42, v232, v24, 0
  v_dot2_f32_bf16 v40, v225, v17, v40
  v_dot2_f32_bf16 v41, v229, v21, v41
  v_dot2_f32_bf16 v42, v233, v25, v42
  v_dot2_f32_bf16 v40, v226, v18, v40
  v_dot2_f32_bf16 v41, v230, v22, v41
  v_dot2_f32_bf16 v42, v234, v26, v42
  v_dot2_f32_bf16 v40, v227, v19, v40
  v_dot2_f32_bf16 v41, v231, v23, v41
  v_dot2_f32_bf16 v42, v235, v27, v42
  s_nop 1
  v_add_f32 v40, v40, v41
  v_add_f32 v40, v40, v42
  s_nop 1
  v_add_f32_dpp v40, v40, v40 quad_perm:[1,0,3,2] row_mask:0xf bank_mask:0xf
  s_nop 1
  v_add_f32_dpp v40, v40, v40 quad_perm:[2,3,0,1] row_mask:0xf bank_mask:0xf
  s_nop 1
  v_add_f32_dpp v40, v40, v40 row_half_mirror row_mask:0xf bank_mask:0xf
  v_cvt_pk_bf16_f32 v40, v40, v40
  v_and_b32 v40, 0xffff0000, v40
  v_mul_f32 v40, s46, v40
  v_cvt_pk_bf16_f32 v74, v40, v40
  v_and_b32 v74, 0xffff0000, v74
  v_max_f32 v44, v44, v74
  s_waitcnt vmcnt(4)
  buffer_load_dwordx4 v[88:91], v1, s[32:35], s45 offen offset:256 nt
  s_waitcnt vmcnt(4)
  s_and_b32 s50, s50, 31
  s_mul_i32 s45, s50, 49152
  s_add_u32 s50, s50, 1
  buffer_load_dwordx4 v[92:95], v1, s[32:35], s45 offen offset:0 nt
  s_waitcnt vmcnt(4)
  buffer_load_dwordx4 v[96:99], v1, s[32:35], s45 offen offset:128 nt
  v_dot2_f32_bf16 v40, v236, v16, 0
  v_dot2_f32_bf16 v41, v240, v20, 0
  v_dot2_f32_bf16 v42, v244, v24, 0
  v_dot2_f32_bf16 v40, v237, v17, v40
  v_dot2_f32_bf16 v41, v241, v21, v41
  v_dot2_f32_bf16 v42, v245, v25, v42
  v_dot2_f32_bf16 v40, v238, v18, v40
  v_dot2_f32_bf16 v41, v242, v22, v41
  v_dot2_f32_bf16 v42, v246, v26, v42
  v_dot2_f32_bf16 v40, v239, v19, v40
  v_dot2_f32_bf16 v41, v243, v23, v41
  v_dot2_f32_bf16 v42, v247, v27, v42
  s_nop 1
  v_add_f32 v40, v40, v41
  v_add_f32 v40, v40, v42
  s_nop 1
  v_add_f32_dpp v40, v40, v40 quad_perm:[1,0,3,2] row_mask:0xf bank_mask:0xf
  s_nop 1
  v_add_f32_dpp v40, v40, v40 quad_perm:[2,3,0,1] row_mask:0xf bank_mask:0xf
  s_nop 1
  v_add_f32_dpp v40, v40, v40 row_half_mirror row_mask:0xf bank_mask:0xf
  v_cvt_pk_bf16_f32 v40, v40, v40
  v_and_b32 v40, 0xffff0000, v40
  v_mul_f32 v40, s46, v40
  v_cvt_pk_bf16_f32 v75, v40, v40
  v_and_b32 v75, 0xffff0000, v75
  v_max_f32 v44, v44, v75
  s_waitcnt vmcnt(4)
  buffer_load_dwordx4 v[100:103], v1, s[32:35], s45 offen offset:256 nt
  s_waitcnt vmcnt(4)
  s_and_b32 s50, s50, 31
  s_mul_i32 s45, s50, 49152
  s_add_u32 s50, s50, 1
  buffer_load_dwordx4 v[104:107], v1, s[32:35], s45 offen offset:0 nt
  s_waitcnt vmcnt(4)
  buffer_load_dwordx4 v[108:111], v1, s[32:35], s45 offen offset:128 nt
  v_dot2_f32_bf16 v40, v80, v16, 0
  v_dot2_f32_bf16 v41, v84, v20, 0
  v_dot2_f32_bf16 v42, v88, v24, 0
  v_dot2_f32_bf16 v40, v81, v17, v40
  v_dot2_f32_bf16 v41, v85, v21, v41
  v_dot2_f32_bf16 v42, v89, v25, v42
  v_dot2_f32_bf16 v40, v82, v18, v40
  v_dot2_f32_bf16 v41, v86, v22, v41
  v_dot2_f32_bf16 v42, v90, v26, v42
  v_dot2_f32_bf16 v40, v83, v19, v40
  v_dot2_f32_bf16 v41, v87, v23, v41
  v_dot2_f32_bf16 v42, v91, v27, v42
  s_nop 1
  v_add_f32 v40, v40, v41
  v_add_f32 v40, v40, v42
  s_nop 1
  v_add_f32_dpp v40, v40, v40 quad_perm:[1,0,3,2] row_mask:0xf bank_mask:0xf
  s_nop 1
  v_add_f32_dpp v40, v40, v40 quad_perm:[2,3,0,1] row_mask:0xf bank_mask:0xf
  s_nop 1
  v_add_f32_dpp v40, v40, v40 row_half_mirror row_mask:0xf bank_mask:0xf
  v_cvt_pk_bf16_f32 v40, v40, v40
  v_and_b32 v40, 0xffff0000, v40
  v_mul_f32 v40, s46, v40
  v_cvt_pk_bf16_f32 v76, v40, v40
  v_and_b32 v76, 0xffff0000, v76
  v_max_f32 v44, v44, v76
  s_waitcnt vmcnt(4)
  buffer_load_dwordx4 v[112:115], v1, s[32:35], s45 offen offset:256 nt
  s_waitcnt vmcnt(4)
  s_and_b32 s50, s50, 31
  s_mul_i32 s45, s50, 49152
  s_add_u32 s50, s50, 1
  buffer_load_dwordx4 v[116:119], v1, s[32:35], s45 offen offset:0 nt
  s_waitcnt vmcnt(4)
  buffer_load_dwordx4 v[120:123], v1, s[32:35], s45 offen offset:128 nt
  v_dot2_f32_bf16 v40, v92, v16, 0
  v_dot2_f32_bf16 v41, v96, v20, 0
  v_dot2_f32_bf16 v42, v100, v24, 0
  v_dot2_f32_bf16 v40, v93, v17, v40
  v_dot2_f32_bf16 v41, v97, v21, v41
  v_dot2_f32_bf16 v42, v101, v25, v42
  v_dot2_f32_bf16 v40, v94, v18, v40
  v_dot2_f32_bf16 v41, v98, v22, v41
  v_dot2_f32_bf16 v42, v102, v26, v42
  v_dot2_f32_bf16 v40, v95, v19, v40
  v_dot2_f32_bf16 v41, v99, v23, v41
  v_dot2_f32_bf16 v42, v103, v27, v42
  s_nop 1
  v_add_f32 v40, v40, v41
  v_add_f32 v40, v40, v42
  s_nop 1
  v_add_f32_dpp v40, v40, v40 quad_perm:[1,0,3,2] row_mask:0xf bank_mask:0xf
  s_nop 1
  v_add_f32_dpp v40, v40, v40 quad_perm:[2,3,0,1] row_mask:0xf bank_mask:0xf
  s_nop 1
  v_add_f32_dpp v40, v40, v40 row_half_mirror row_mask:0xf bank_mask:0xf
  v_cvt_pk_bf16_f32 v40, v40, v40
  v_and_b32 v40, 0xffff0000, v40
  v_mul_f32 v40, s46, v40
  v_cvt_pk_bf16_f32 v77, v40, v40
  v_and_b32 v77, 0xffff0000, v77
  v_max_f32 v44, v44, v77
  s_waitcnt vmcnt(4)
  buffer_load_dwordx4 v[124:127], v1, s[32:35], s45 offen offset:256 nt
  s_mov_b64 exec, 1
  ds_add_u32 v248, v249 offset:10788
  s_mov_b64 exec, -1
  s_waitcnt vmcnt(4)
  s_and_b32 s50, s50, 31
  s_mul_i32 s45, s50, 49152
  s_add_u32 s50, s50, 1
  buffer_load_dwordx4 v[128:131], v1, s[36:39], s45 offen offset:0 nt
  s_waitcnt vmcnt(4)
  buffer_load_dwordx4 v[132:135], v1, s[36:39], s45 offen offset:128 nt
  v_dot2_f32_bf16 v40, v104, v16, 0
  v_dot2_f32_bf16 v41, v108, v20, 0
  v_dot2_f32_bf16 v42, v112, v24, 0
  v_dot2_f32_bf16 v40, v105, v17, v40
  v_dot2_f32_bf16 v41, v109, v21, v41
  v_dot2_f32_bf16 v42, v113, v25, v42
  v_dot2_f32_bf16 v40, v106, v18, v40
  v_dot2_f32_bf16 v41, v110, v22, v41
  v_dot2_f32_bf16 v42, v114, v26, v42
  v_dot2_f32_bf16 v40, v107, v19, v40
  v_dot2_f32_bf16 v41, v111, v23, v41
  v_dot2_f32_bf16 v42, v115, v27, v42
  s_nop 1
  v_add_f32 v40, v40, v41
  v_add_f32 v40, v40, v42
  s_nop 1
  v_add_f32_dpp v40, v40, v40 quad_perm:[1,0,3,2] row_mask:0xf bank_mask:0xf
  s_nop 1
  v_add_f32_dpp v40, v40, v40 quad_perm:[2,3,0,1] row_mask:0xf bank_mask:0xf
  s_nop 1
  v_add_f32_dpp v40, v40, v40 row_half_mirror row_mask:0xf bank_mask:0xf
  v_cvt_pk_bf16_f32 v40, v40, v40
  v_and_b32 v40, 0xffff0000, v40
  v_mul_f32 v40, s46, v40
  v_cvt_pk_bf16_f32 v78, v40, v40
  v_and_b32 v78, 0xffff0000, v78
  v_max_f32 v44, v44, v78
  s_waitcnt vmcnt(4)
  buffer_load_dwordx4 v[136:139], v1, s[36:39], s45 offen offset:256 nt
  s_waitcnt vmcnt(4)
  s_and_b32 s50, s50, 31
  s_mul_i32 s45, s50, 49152
  s_add_u32 s50, s50, 1
  buffer_load_dwordx4 v[140:143], v1, s[36:39], s45 offen offset:0 nt
  s_waitcnt vmcnt(4)
  buffer_load_dwordx4 v[144:147], v1, s[36:39], s45 offen offset:128 nt
  v_dot2_f32_bf16 v40, v116, v16, 0
  v_dot2_f32_bf16 v41, v120, v20, 0
  v_dot2_f32_bf16 v42, v124, v24, 0
  v_dot2_f32_bf16 v40, v117, v17, v40
  v_dot2_f32_bf16 v41, v121, v21, v41
  v_dot2_f32_bf16 v42, v125, v25, v42
  v_dot2_f32_bf16 v40, v118, v18, v40
  v_dot2_f32_bf16 v41, v122, v22, v41
  v_dot2_f32_bf16 v42, v126, v26, v42
  v_dot2_f32_bf16 v40, v119, v19, v40
  v_dot2_f32_bf16 v41, v123, v23, v41
  v_dot2_f32_bf16 v42, v127, v27, v42
  s_nop 1
  v_add_f32 v40, v40, v41
  v_add_f32 v40, v40, v42
  s_nop 1
  v_add_f32_dpp v40, v40, v40 quad_perm:[1,0,3,2] row_mask:0xf bank_mask:0xf
  s_nop 1
  v_add_f32_dpp v40, v40, v40 quad_perm:[2,3,0,1] row_mask:0xf bank_mask:0xf
  s_nop 1
  v_add_f32_dpp v40, v40, v40 row_half_mirror row_mask:0xf bank_mask:0xf
  v_cvt_pk_bf16_f32 v40, v40, v40
  v_and_b32 v40, 0xffff0000, v40
  v_mul_f32 v40, s46, v40
  v_cvt_pk_bf16_f32 v79, v40, v40
  v_and_b32 v79, 0xffff0000, v79
  v_max_f32 v44, v44, v79
  s_memrealtime s[52:53]
  buffer_load_dwordx4 v[148:151], v1, s[36:39], s45 offen offset:256 nt
  v_max_f32_dpp v44, v44, v44 row_ror:8 row_mask:0xf bank_mask:0xf
  v_mov_b32 v40, v44
  s_nop 1
  v_permlane16_swap_b32 v40, v44
  v_max_f32 v44, v40, v44
  v_mov_b32 v40, v44
  s_nop 1
  v_permlane32_swap_b32 v40, v44
  v_max_f32 v44, v40, v44
  v_sub_f32 v48, v48, v44
  v_mul_f32 v48, s47, v48
  v_exp_f32 v48, v48
  v_sub_f32 v49, v49, v44
  v_mul_f32 v49, s47, v49
  v_exp_f32 v49, v49
  v_mov_b32 v45, v48
  v_cvt_pk_bf16_f32 v48, v48, v48
  v_sub_f32 v50, v50, v44
  v_mul_f32 v50, s47, v50
  v_exp_f32 v50, v50
  v_add_f32 v45, v45, v49
  v_cvt_pk_bf16_f32 v49, v49, v49
  v_sub_f32 v51, v51, v44
  v_mul_f32 v51, s47, v51
  v_exp_f32 v51, v51
  v_add_f32 v45, v45, v50
  v_cvt_pk_bf16_f32 v50, v50, v50
  v_sub_f32 v52, v52, v44
  v_mul_f32 v52, s47, v52
  v_exp_f32 v52, v52
  v_add_f32 v45, v45, v51
  v_cvt_pk_bf16_f32 v51, v51, v51
  v_sub_f32 v53, v53, v44
  v_mul_f32 v53, s47, v53
  v_exp_f32 v53, v53
  v_add_f32 v45, v45, v52
  v_cvt_pk_bf16_f32 v52, v52, v52
  v_sub_f32 v54, v54, v44
  v_mul_f32 v54, s47, v54
  v_exp_f32 v54, v54
  v_add_f32 v45, v45, v53
  v_cvt_pk_bf16_f32 v53, v53, v53
  v_sub_f32 v55, v55, v44
  v_mul_f32 v55, s47, v55
  v_exp_f32 v55, v55
  v_add_f32 v45, v45, v54
  v_cvt_pk_bf16_f32 v54, v54, v54
  v_sub_f32 v56, v56, v44
  v_mul_f32 v56, s47, v56
  v_exp_f32 v56, v56
  v_add_f32 v45, v45, v55
  v_cvt_pk_bf16_f32 v55, v55, v55
  s_waitcnt vmcnt(5)
  s_and_b32 s50, s50, 31
  s_mul_i32 s45, s50, 49152
  s_add_u32 s50, s50, 1
  buffer_load_dwordx4 v[152:155], v1, s[36:39], s45 offen offset:0 nt
  v_sub_f32 v57, v57, v44
  v_mul_f32 v57, s47, v57
  v_exp_f32 v57, v57
  v_add_f32 v45, v45, v56
  v_cvt_pk_bf16_f32 v56, v56, v56
  v_sub_f32 v58, v58, v44
  v_mul_f32 v58, s47, v58
  v_exp_f32 v58, v58
  v_add_f32 v45, v45, v57
  v_cvt_pk_bf16_f32 v57, v57, v57
  v_sub_f32 v59, v59, v44
  v_mul_f32 v59, s47, v59
  v_exp_f32 v59, v59
  v_add_f32 v45, v45, v58
  v_cvt_pk_bf16_f32 v58, v58, v58
  v_sub_f32 v60, v60, v44
  v_mul_f32 v60, s47, v60
  v_exp_f32 v60, v60
  v_add_f32 v45, v45, v59
  v_cvt_pk_bf16_f32 v59, v59, v59
  v_sub_f32 v61, v61, v44
  v_mul_f32 v61, s47, v61
  v_exp_f32 v61, v61
  v_add_f32 v45, v45, v60
  v_cvt_pk_bf16_f32 v60, v60, v60
  v_sub_f32 v62, v62, v44
  v_mul_f32 v62, s47, v62
  v_exp_f32 v62, v62
  v_add_f32 v45, v45, v61
  v_cvt_pk_bf16_f32 v61, v61, v61
  v_sub_f32 v63, v63, v44
  v_mul_f32 v63, s47, v63
  v_exp_f32 v63, v63
  v_add_f32 v45, v45, v62
  v_cvt_pk_bf16_f32 v62, v62, v62
  v_sub_f32 v64, v64, v44
  v_mul_f32 v64, s47, v64
  v_exp_f32 v64, v64
  v_add_f32 v45, v45, v63
  v_cvt_pk_bf16_f32 v63, v63, v63
  v_sub_f32 v65, v65, v44
  v_mul_f32 v65, s47, v65
  v_exp_f32 v65, v65
  v_add_f32 v45, v45, v64
  v_cvt_pk_bf16_f32 v64, v64, v64
  v_sub_f32 v66, v66, v44
  v_mul_f32 v66, s47, v66
  v_exp_f32 v66, v66
  v_add_f32 v45, v45, v65
  v_cvt_pk_bf16_f32 v65, v65, v65
  s_waitcnt vmcnt(5)
  buffer_load_dwordx4 v[156:159], v1, s[36:39], s45 offen offset:128 nt
  v_sub_f32 v67, v67, v44
  v_mul_f32 v67, s47, v67
  v_exp_f32 v67, v67
  v_add_f32 v45, v45, v66
  v_cvt_pk_bf16_f32 v66, v66, v66
  v_sub_f32 v68, v68, v44
  v_mul_f32 v68, s47, v68
  v_exp_f32 v68, v68
  v_add_f32 v45, v45, v67
  v_cvt_pk_bf16_f32 v67, v67, v67
  v_sub_f32 v69, v69, v44
  v_mul_f32 v69, s47, v69
  v_exp_f32 v69, v69
  v_add_f32 v45, v45, v68
  v_cvt_pk_bf16_f32 v68, v68, v68
  v_sub_f32 v70, v70, v44
  v_mul_f32 v70, s47, v70
  v_exp_f32 v70, v70
  v_add_f32 v45, v45, v69
  v_cvt_pk_bf16_f32 v69, v69, v69
  v_sub_f32 v71, v71, v44
  v_mul_f32 v71, s47, v71
  v_exp_f32 v71, v71
  v_add_f32 v45, v45, v70
  v_cvt_pk_bf16_f32 v70, v70, v70
  v_sub_f32 v72, v72, v44
  v_mul_f32 v72, s47, v72
  v_exp_f32 v72, v72
  v_add_f32 v45, v45, v71
  v_cvt_pk_bf16_f32 v71, v71, v71
  v_sub_f32 v73, v73, v44
  v_mul_f32 v73, s47, v73
  v_exp_f32 v73, v73
  v_add_f32 v45, v45, v72
  v_cvt_pk_bf16_f32 v72, v72, v72
  v_sub_f32 v74, v74, v44
  v_mul_f32 v74, s47, v74
  v_exp_f32 v74, v74
  v_add_f32 v45, v45, v73
  v_cvt_pk_bf16_f32 v73, v73, v73
  v_sub_f32 v75, v75, v44
  v_mul_f32 v75, s47, v75
  v_exp_f32 v75, v75
  v_add_f32 v45, v45, v74
  v_cvt_pk_bf16_f32 v74, v74, v74
  v_sub_f32 v76, v76, v44
  v_mul_f32 v76, s47, v76
  v_exp_f32 v76, v76
  v_add_f32 v45, v45, v75
  v_cvt_pk_bf16_f32 v75, v75, v75
  s_waitcnt vmcnt(5)
  buffer_load_dwordx4 v[160:163], v1, s[36:39], s45 offen offset:256 nt
  v_sub_f32 v77, v77, v44
  v_mul_f32 v77, s47, v77
  v_exp_f32 v77, v77
  v_add_f32 v45, v45, v76
  v_cvt_pk_bf16_f32 v76, v76, v76
  v_sub_f32 v78, v78, v44
  v_mul_f32 v78, s47, v78
  v_exp_f32 v78, v78
  v_add_f32 v45, v45, v77
  v_cvt_pk_bf16_f32 v77, v77, v77
  v_sub_f32 v79, v79, v44
  v_mul_f32 v79, s47, v79
  v_exp_f32 v79, v79
  v_add_f32 v45, v45, v78
  v_cvt_pk_bf16_f32 v78, v78, v78
  v_add_f32 v45, v45, v79
  v_cvt_pk_bf16_f32 v79, v79, v79
  s_nop 0
  v_add_f32_dpp v45, v45, v45 row_ror:8 row_mask:0xf bank_mask:0xf
  v_mov_b32 v40, v45
  s_nop 1
  v_permlane16_swap_b32 v40, v45
  v_add_f32 v45, v40, v45
  v_mov_b32 v40, v45
  s_nop 1
  v_permlane32_swap_b32 v40, v45
  v_add_f32 v45, v40, v45
  s_waitcnt lgkmcnt(0)
  s_and_b32 s52, s52, 0xffff
  v_or_b32 v44, s52, v44
  s_mov_b64 exec, 1
  ds_write_b64 v250, v[44:45] offset:10880
  ds_add_u32 v248, v249 offset:10768
  s_mov_b64 exec, -1
  v_and_b32 v8, v48, v4
  v_and_b32 v9, v48, v5
  v_and_b32 v10, v48, v6
  v_and_b32 v11, v48, v7
  v_mov_b32 v251, 105
  ds_write_b32 v250, v251 offset:10912
  ds_read_b64 v[252:253], v250 offset:10832
  s_cmpk_gt_i32 s54, 105
  s_cbranch_scc1 L_sk_3
  s_waitcnt vmcnt(4)
  s_cmpk_le_i32 s58, 105
  s_cbranch_scc1 L_sk_3
  s_waitcnt vmcnt(3)
L_sk_3:
  s_and_b32 s50, s50, 31
  s_mul_i32 s45, s50, 49152
  s_add_u32 s50, s50, 1
  buffer_load_dwordx4 v[164:167], v1, s[36:39], s45 offen offset:0 nt
  v_mfma_f32_16x16x32_bf16 v[28:31], v[128:131], v[8:11], 0
  v_mfma_f32_16x16x32_bf16 v[32:35], v[132:135], v[8:11], 0
  v_mfma_f32_16x16x32_bf16 v[36:39], v[136:139], v[8:11], 0
  v_and_b32 v12, v49, v4
  v_and_b32 v13, v49, v5
  v_and_b32 v14, v49, v6
  v_and_b32 v15, v49, v7
  v_lshrrev_b32 v2, 4, v0
  v_lshrrev_b32 v3, 1, v2
  s_lshl_b32 s48, s24, 1
  v_add_u32 v3, s48, v3
  v_mul_u32_u24 v3, 768, v3
  v_and_b32 v2, 1, v2
  s_waitcnt vmcnt(6)
  s_cmpk_gt_i32 s54, 106
  s_cbranch_scc1 L_sk_4
  s_waitcnt vmcnt(4)
  s_cmpk_le_i32 s58, 106
  s_cbranch_scc1 L_sk_4
  s_waitcnt vmcnt(3)
L_sk_4:
  buffer_load_dwordx4 v[168:171], v1, s[36:39], s45 offen offset:128 nt
  s_waitcnt vmcnt(6)
  s_cmpk_gt_i32 s54, 107
  s_cbranch_scc1 L_sk_5
  s_waitcnt vmcnt(4)
  s_cmpk_le_i32 s58, 107
  s_cbranch_scc1 L_sk_5
  s_waitcnt vmcnt(3)
L_sk_5:
  buffer_load_dwordx4 v[172:175], v1, s[36:39], s45 offen offset:256 nt
  s_waitcnt lgkmcnt(0)
  v_readfirstlane_b32 s54, v252
  v_readfirstlane_b32 s58, v253
  v_mov_b32 v251, 108
  ds_write_b32 v250, v251 offset:10912
  ds_read_b64 v[252:253], v250 offset:10832
  s_waitcnt vmcnt(6)
  s_cmpk_gt_i32 s54, 108
  s_cbranch_scc1 L_sk_6
  s_waitcnt vmcnt(4)
  s_cmpk_le_i32 s58, 108
  s_cbranch_scc1 L_sk_6
  s_waitcnt vmcnt(3)
L_sk_6:
  s_and_b32 s50, s50, 31
  s_mul_i32 s45, s50, 49152
  s_add_u32 s50, s50, 1
  buffer_load_dwordx4 v[176:179], v1, s[36:39], s45 offen offset:0 nt
  v_mfma_f32_16x16x32_bf16 v[28:31], v[140:143], v[12:15], v[28:31]
  v_mfma_f32_16x16x32_bf16 v[32:35], v[144:147], v[12:15], v[32:35]
  v_mfma_f32_16x16x32_bf16 v[36:39], v[148:151], v[12:15], v[36:39]
  v_and_b32 v8, v50, v4
  v_and_b32 v9, v50, v5
  v_and_b32 v10, v50, v6
  v_and_b32 v11, v50, v7
  v_lshl_add_u32 v3, v2, 4, v3
  v_and_b32 v2, 7, v0
  v_lshl_add_u32 v3, v2, 5, v3
  v_lshlrev_b32 v2, 4, v0
  s_lshl_b32 s48, s2, 9
  s_add_u32 s48, s48, 561152
  s_waitcnt vmcnt(6)
  s_cmpk_gt_i32 s54, 109
  s_cbranch_scc1 L_sk_7
  s_waitcnt vmcnt(4)
  s_cmpk_le_i32 s58, 109
  s_cbranch_scc1 L_sk_7
  s_waitcnt vmcnt(3)
L_sk_7:
  buffer_load_dwordx4 v[180:183], v1, s[36:39], s45 offen offset:128 nt
  s_waitcnt vmcnt(6)
  s_cmpk_gt_i32 s54, 110
  s_cbranch_scc1 L_sk_8
  s_waitcnt vmcnt(4)
  s_cmpk_le_i32 s58, 110
  s_cbranch_scc1 L_sk_8
  s_waitcnt vmcnt(3)
L_sk_8:
  buffer_load_dwordx4 v[184:187], v1, s[36:39], s45 offen offset:256 nt
  s_waitcnt lgkmcnt(0)
  v_readfirstlane_b32 s54, v252
  v_readfirstlane_b32 s58, v253
  v_mov_b32 v251, 111
  ds_write_b32 v250, v251 offset:10912
  ds_read_b64 v[252:253], v250 offset:10832
  s_waitcnt vmcnt(6)
  s_cmpk_gt_i32 s54, 111
  s_cbranch_scc1 L_sk_9
  s_waitcnt vmcnt(4)
  s_cmpk_le_i32 s58, 111
  s_cbranch_scc1 L_sk_9
  s_waitcnt vmcnt(3)
L_sk_9:
  s_and_b32 s50, s50, 31
  s_mul_i32 s45, s50, 49152
  s_add_u32 s50, s50, 1
  buffer_load_dwordx4 v[188:191], v1, s[36:39], s45 offen offset:0 nt
  v_mfma_f32_16x16x32_bf16 v[28:31], v[152:155], v[8:11], v[28:31]
  v_mfma_f32_16x16x32_bf16 v[32:35], v[156:159], v[8:11], v[32:35]
  v_mfma_f32_16x16x32_bf16 v[36:39], v[160:163], v[8:11], v[36:39]
  v_and_b32 v12, v51, v4
  v_and_b32 v13, v51, v5
  v_and_b32 v14, v51, v6
  v_and_b32 v15, v51, v7
  v_mov_b32 v22, s30
  v_mov_b32 v23, s30
  s_lshl_b32 s56, s25, 12
  s_lshl_b32 s49, s24, 10
  s_add_u32 s56, s56, s49
  s_add_u32 s56, s56, 561152
  s_waitcnt vmcnt(6)
  s_cmpk_gt_i32 s54, 112
  s_cbranch_scc1 L_sk_10
  s_waitcnt vmcnt(4)
  s_cmpk_le_i32 s58, 112
  s_cbranch_scc1 L_sk_10
  s_waitcnt vmcnt(3)
L_sk_10:
  buffer_load_dwordx4 v[192:195], v1, s[36:39], s45 offen offset:128 nt
  s_waitcnt vmcnt(6)
  s_cmpk_gt_i32 s54, 113
  s_cbranch_scc1 L_sk_11
  s_waitcnt vmcnt(4)
  s_cmpk_le_i32 s58, 113
  s_cbranch_scc1 L_sk_11
  s_waitcnt vmcnt(3)
L_sk_11:
  buffer_load_dwordx4 v[196:199], v1, s[36:39], s45 offen offset:256 nt
  s_waitcnt lgkmcnt(0)
  v_readfirstlane_b32 s54, v252
  v_readfirstlane_b32 s58, v253
  v_mov_b32 v251, 114
  ds_write_b32 v250, v251 offset:10912
  ds_read_b64 v[252:253], v250 offset:10832
  s_waitcnt vmcnt(6)
  s_cmpk_gt_i32 s54, 114
  s_cbranch_scc1 L_sk_12
  s_waitcnt vmcnt(4)
  s_cmpk_le_i32 s58, 114
  s_cbranch_scc1 L_sk_12
  s_waitcnt vmcnt(3)
L_sk_12:
  s_and_b32 s50, s50, 31
  s_mul_i32 s45, s50, 49152
  s_add_u32 s50, s50, 1
  buffer_load_dwordx4 v[200:203], v1, s[36:39], s45 offen offset:0 nt
  v_mfma_f32_16x16x32_bf16 v[28:31], v[164:167], v[12:15], v[28:31]
  v_mfma_f32_16x16x32_bf16 v[32:35], v[168:171], v[12:15], v[32:35]
  v_mfma_f32_16x16x32_bf16 v[36:39], v[172:175], v[12:15], v[36:39]
  v_and_b32 v8, v52, v4
  v_and_b32 v9, v52, v5
  v_and_b32 v10, v52, v6
  v_and_b32 v11, v52, v7
  v_lshrrev_b32 v24, 5, v0
  v_and_b32 v25, 31, v0
  v_mul_u32_u24 v46, 3072, v24
  v_lshl_add_u32 v46, v25, 3, v46
  v_lshlrev_b32 v47, 3, v24
  s_mul_i32 s49, s24, 800
  s_waitcnt vmcnt(6)
  s_cmpk_gt_i32 s54, 115
  s_cbranch_scc1 L_sk_13
  s_waitcnt vmcnt(4)
  s_cmpk_le_i32 s58, 115
  s_cbranch_scc1 L_sk_13
  s_waitcnt vmcnt(3)
L_sk_13:
  buffer_load_dwordx4 v[204:207], v1, s[36:39], s45 offen offset:128 nt
  s_waitcnt vmcnt(6)
  s_cmpk_gt_i32 s54, 116
  s_cbranch_scc1 L_sk_14
  s_waitcnt vmcnt(4)
  s_cmpk_le_i32 s58, 116
  s_cbranch_scc1 L_sk_14
  s_waitcnt vmcnt(3)
L_sk_14:
  buffer_load_dwordx4 v[208:211], v1, s[36:39], s45 offen offset:256 nt
  s_waitcnt lgkmcnt(0)
  v_readfirstlane_b32 s54, v252
  v_readfirstlane_b32 s58, v253
  v_mov_b32 v251, 117
  ds_write_b32 v250, v251 offset:10912
  ds_read_b64 v[252:253], v250 offset:10832
  s_waitcnt vmcnt(6)
  s_cmpk_gt_i32 s54, 117
  s_cbranch_scc1 L_sk_15
  s_waitcnt vmcnt(4)
  s_cmpk_le_i32 s58, 117
  s_cbranch_scc1 L_sk_15
  s_waitcnt vmcnt(3)
L_sk_15:
  s_and_b32 s50, s50, 31
  s_mul_i32 s45, s50, 49152
  s_add_u32 s50, s50, 1
  buffer_load_dwordx4 v[212:215], v1, s[36:39], s45 offen offset:0 nt
  v_mfma_f32_16x16x32_bf16 v[28:31], v[176:179], v[8:11], v[28:31]
  v_mfma_f32_16x16x32_bf16 v[32:35], v[180:183], v[8:11], v[32:35]
  v_mfma_f32_16x16x32_bf16 v[36:39], v[184:187], v[8:11], v[36:39]
  v_and_b32 v12, v53, v4
  v_and_b32 v13, v53, v5
  v_and_b32 v14, v53, v6
  v_and_b32 v15, v53, v7
  s_add_u32 s49, s49, 17152
  v_mul_u32_u24 v43, 400, v24
  v_lshl_add_u32 v43, v25, 2, v43
  v_add_u32 v43, s49, v43
  s_mul_i32 s49, s26, 400
  s_add_u32 s49, s49, 17152
  s_waitcnt vmcnt(6)
  s_cmpk_gt_i32 s54, 118
  s_cbranch_scc1 L_sk_16
  s_waitcnt vmcnt(4)
  s_cmpk_le_i32 s58, 118
  s_cbranch_scc1 L_sk_16
  s_waitcnt vmcnt(3)
L_sk_16:
  buffer_load_dwordx4 v[216:219], v1, s[36:39], s45 offen offset:128 nt
  s_waitcnt vmcnt(6)
  s_cmpk_gt_i32 s54, 119
  s_cbranch_scc1 L_sk_17
  s_waitcnt vmcnt(4)
  s_cmpk_le_i32 s58, 119
  s_cbranch_scc1 L_sk_17
  s_waitcnt vmcnt(3)
L_sk_17:
  buffer_load_dwordx4 v[220:223], v1, s[36:39], s45 offen offset:256 nt
  s_waitcnt lgkmcnt(0)
  v_readfirstlane_b32 s54, v252
  v_readfirstlane_b32 s58, v253
  v_mov_b32 v251, 120
  ds_write_b32 v250, v251 offset:10912
  ds_read_b64 v[252:253], v250 offset:10832
  s_waitcnt vmcnt(6)
  s_cmpk_gt_i32 s54, 120
  s_cbranch_scc1 L_sk_18
  s_waitcnt vmcnt(4)
  s_cmpk_le_i32 s58, 120
  s_cbranch_scc1 L_sk_18
  s_waitcnt vmcnt(3)
L_sk_18:
  s_and_b32 s50, s50, 31
  s_mul_i32 s45, s50, 49152
  s_add_u32 s50, s50, 1
  buffer_load_dwordx4 v[224:227], v1, s[36:39], s45 offen offset:0 nt
  v_mfma_f32_16x16x32_bf16 v[28:31], v[188:191], v[12:15], v[28:31]
  v_mfma_f32_16x16x32_bf16 v[32:35], v[192:195], v[12:15], v[32:35]
  v_mfma_f32_16x16x32_bf16 v[36:39], v[196:199], v[12:15], v[36:39]
  v_and_b32 v8, v54, v4
  v_and_b32 v9, v54, v5
  v_and_b32 v10, v54, v6
  v_and_b32 v11, v54, v7
  v_lshlrev_b32 v42, 2, v25
  v_add_u32 v42, s49, v42
  s_lshr_b32 s49, s26, 1
  s_and_b32 s61, s26, 1
  s_cmp_eq_u32 s49, s24
  s_cselect_b32 s61, s61, 2
  s_waitcnt vmcnt(6)
  s_cmpk_gt_i32 s54, 121
  s_cbranch_scc1 L_sk_19
  s_waitcnt vmcnt(4)
  s_cmpk_le_i32 s58, 121
  s_cbranch_scc1 L_sk_19
  s_waitcnt vmcnt(3)
L_sk_19:
  buffer_load_dwordx4 v[228:231], v1, s[36:39], s45 offen offset:128 nt
  s_waitcnt vmcnt(6)
  s_cmpk_gt_i32 s54, 122
  s_cbranch_scc1 L_sk_20
  s_waitcnt vmcnt(4)
  s_cmpk_le_i32 s58, 122
  s_cbranch_scc1 L_sk_20
  s_waitcnt vmcnt(3)
L_sk_20:
  buffer_load_dwordx4 v[232:235], v1, s[36:39], s45 offen offset:256 nt
  s_waitcnt lgkmcnt(0)
  v_readfirstlane_b32 s54, v252
  v_readfirstlane_b32 s58, v253
  v_mov_b32 v251, 123
  ds_write_b32 v250, v251 offset:10912
  ds_read_b64 v[252:253], v250 offset:10832
  s_waitcnt vmcnt(6)
  s_cmpk_gt_i32 s54, 123
  s_cbranch_scc1 L_sk_21
  s_waitcnt vmcnt(4)
  s_cmpk_le_i32 s58, 123
  s_cbranch_scc1 L_sk_21
  s_waitcnt vmcnt(3)
L_sk_21:
  s_and_b32 s50, s50, 31
  s_mul_i32 s45, s50, 49152
  s_add_u32 s50, s50, 1
  buffer_load_dwordx4 v[236:239], v1, s[36:39], s45 offen offset:0 nt
  v_mfma_f32_16x16x32_bf16 v[28:31], v[200:203], v[8:11], v[28:31]
  v_mfma_f32_16x16x32_bf16 v[32:35], v[204:207], v[8:11], v[32:35]
  v_mfma_f32_16x16x32_bf16 v[36:39], v[208:211], v[8:11], v[36:39]
  v_and_b32 v12, v55, v4
  v_and_b32 v13, v55, v5
  v_and_b32 v14, v55, v6
  v_and_b32 v15, v55, v7
  s_cmp_eq_u32 s61, 0
  s_cselect_b32 s59, 0, -1
  s_cmp_eq_u32 s61, 1
  s_cselect_b32 s60, 0, -1
  s_lshr_b32 s49, s26, 1
  s_and_b32 s55, s25, 3
  s_waitcnt vmcnt(6)
  s_cmpk_gt_i32 s54, 124
  s_cbranch_scc1 L_sk_22
  s_waitcnt vmcnt(4)
  s_cmpk_le_i32 s58, 124
  s_cbranch_scc1 L_sk_22
  s_waitcnt vmcnt(3)
L_sk_22:
  buffer_load_dwordx4 v[240:243], v1, s[36:39], s45 offen offset:128 nt
  s_waitcnt vmcnt(6)
  s_cmpk_gt_i32 s54, 125
  s_cbranch_scc1 L_sk_23
  s_waitcnt vmcnt(4)
  s_cmpk_le_i32 s58, 125
  s_cbranch_scc1 L_sk_23
  s_waitcnt vmcnt(3)
L_sk_23:
  buffer_load_dwordx4 v[244:247], v1, s[36:39], s45 offen offset:256 nt
  s_mov_b64 exec, 1
  ds_add_u32 v248, v249 offset:10788
  s_mov_b64 exec, -1
  s_waitcnt lgkmcnt(0)
  v_readfirstlane_b32 s54, v252
  v_readfirstlane_b32 s58, v253
  v_mov_b32 v251, 126
  ds_write_b32 v250, v251 offset:10912
  ds_read_b64 v[252:253], v250 offset:10832
  s_waitcnt vmcnt(6)
  s_cmpk_gt_i32 s54, 126
  s_cbranch_scc1 L_sk_24
  s_waitcnt vmcnt(4)
  s_cmpk_le_i32 s58, 126
  s_cbranch_scc1 L_sk_24
  s_waitcnt vmcnt(3)
L_sk_24:
  s_and_b32 s50, s50, 31
  s_mul_i32 s45, s50, 49152
  s_add_u32 s50, s50, 1
  buffer_load_dwordx4 v[80:83], v1, s[36:39], s45 offen offset:0 nt
  v_mfma_f32_16x16x32_bf16 v[28:31], v[212:215], v[12:15], v[28:31]
  v_mfma_f32_16x16x32_bf16 v[32:35], v[216:219], v[12:15], v[32:35]
  v_mfma_f32_16x16x32_bf16 v[36:39], v[220:223], v[12:15], v[36:39]
  v_and_b32 v8, v56, v4
  v_and_b32 v9, v56, v5
  v_and_b32 v10, v56, v6
  v_and_b32 v11, v56, v7
  s_cmp_eq_u32 s49, s55
  s_cselect_b32 s55, 1, 0
  s_bitcmp0_b32 s26, 0
  s_cselect_b32 s55, 1, s55
  v_add_u32 v46, 11008, v46
  v_add_u32 v45, 1536, v46
  s_waitcnt vmcnt(6)
  s_cmpk_gt_i32 s54, 127
  s_cbranch_scc1 L_sk_25
  s_waitcnt vmcnt(4)
  s_cmpk_le_i32 s58, 127
  s_cbranch_scc1 L_sk_25
  s_waitcnt vmcnt(3)
L_sk_25:
  buffer_load_dwordx4 v[84:87], v1, s[36:39], s45 offen offset:128 nt
  s_waitcnt vmcnt(6)
  s_cmpk_gt_i32 s54, 128
  s_cbranch_scc1 L_sk_26
  s_waitcnt vmcnt(4)
  s_cmpk_le_i32 s58, 128
  s_cbranch_scc1 L_sk_26
  s_waitcnt vmcnt(3)
L_sk_26:
  buffer_load_dwordx4 v[88:91], v1, s[36:39], s45 offen offset:256 nt
  s_waitcnt lgkmcnt(0)
  v_readfirstlane_b32 s54, v252
  v_readfirstlane_b32 s58, v253
  v_mov_b32 v251, 129
  ds_write_b32 v250, v251 offset:10912
  ds_read_b64 v[252:253], v250 offset:10832
  s_waitcnt vmcnt(6)
  s_cmpk_gt_i32 s54, 129
  s_cbranch_scc1 L_sk_27
  s_waitcnt vmcnt(4)
  s_cmpk_le_i32 s58, 129
  s_cbranch_scc1 L_sk_27
  s_waitcnt vmcnt(3)
L_sk_27:
  s_and_b32 s50, s50, 31
  s_mul_i32 s45, s50, 49152
  s_add_u32 s50, s50, 1
  buffer_load_dwordx4 v[92:95], v1, s[36:39], s45 offen offset:0 nt
  v_mfma_f32_16x16x32_bf16 v[28:31], v[224:227], v[8:11], v[28:31]
  v_mfma_f32_16x16x32_bf16 v[32:35], v[228:231], v[8:11], v[32:35]
  v_mfma_f32_16x16x32_bf16 v[36:39], v[232:235], v[8:11], v[36:39]
  v_and_b32 v12, v57, v4
  v_and_b32 v13, v57, v5
  v_and_b32 v14, v57, v6
  v_and_b32 v15, v57, v7
  s_waitcnt vmcnt(6)
  s_cmpk_gt_i32 s54, 130
  s_cbranch_scc1 L_sk_28
  s_waitcnt vmcnt(4)
  s_cmpk_le_i32 s58, 130
  s_cbranch_scc1 L_sk_28
  s_waitcnt vmcnt(3)
L_sk_28:
  buffer_load_dwordx4 v[96:99], v1, s[36:39], s45 offen offset:128 nt
  s_waitcnt vmcnt(6)
  s_cmpk_gt_i32 s54, 131
  s_cbranch_scc1 L_sk_29
  s_waitcnt vmcnt(4)
  s_cmpk_le_i32 s58, 131
  s_cbranch_scc1 L_sk_29
  s_waitcnt vmcnt(3)
L_sk_29:
  buffer_load_dwordx4 v[100:103], v1, s[36:39], s45 offen offset:256 nt
  s_waitcnt lgkmcnt(0)
  v_readfirstlane_b32 s54, v252
  v_readfirstlane_b32 s58, v253
  v_mov_b32 v251, 132
  ds_write_b32 v250, v251 offset:10912
  ds_read_b64 v[252:253], v250 offset:10832
  s_waitcnt vmcnt(6)
  s_cmpk_gt_i32 s54, 132
  s_cbranch_scc1 L_sk_30
  s_waitcnt vmcnt(4)
  s_cmpk_le_i32 s58, 132
  s_cbranch_scc1 L_sk_30
  s_waitcnt vmcnt(3)
L_sk_30:
  s_and_b32 s50, s50, 31
  s_mul_i32 s45, s50, 49152
  s_add_u32 s50, s50, 1
  buffer_load_dwordx4 v[104:107], v1, s[36:39], s45 offen offset:0 nt
  v_mfma_f32_16x16x32_bf16 v[28:31], v[236:239], v[12:15], v[28:31]
  v_mfma_f32_16x16x32_bf16 v[32:35], v[240:243], v[12:15], v[32:35]
  v_mfma_f32_16x16x32_bf16 v[36:39], v[244:247], v[12:15], v[36:39]
  v_and_b32 v8, v58, v4
  v_and_b32 v9, v58, v5
  v_and_b32 v10, v58, v6
  v_and_b32 v11, v58, v7
  s_waitcnt vmcnt(6)
  s_cmpk_gt_i32 s54, 133
  s_cbranch_scc1 L_sk_31
  s_waitcnt vmcnt(4)
  s_cmpk_le_i32 s58, 133
  s_cbranch_scc1 L_sk_31
  s_waitcnt vmcnt(3)
L_sk_31:
  buffer_load_dwordx4 v[108:111], v1, s[36:39], s45 offen offset:128 nt
  s_waitcnt vmcnt(6)
  s_cmpk_gt_i32 s54, 134
  s_cbranch_scc1 L_sk_32
  s_waitcnt vmcnt(4)
  s_cmpk_le_i32 s58, 134
  s_cbranch_scc1 L_sk_32
  s_waitcnt vmcnt(3)
L_sk_32:
  buffer_load_dwordx4 v[112:115], v1, s[36:39], s45 offen offset:256 nt
  s_waitcnt lgkmcnt(0)
  v_readfirstlane_b32 s54, v252
  v_readfirstlane_b32 s58, v253
  v_mov_b32 v251, 135
  ds_write_b32 v250, v251 offset:10912
  ds_read_b64 v[252:253], v250 offset:10832
  s_waitcnt vmcnt(6)
  s_cmpk_gt_i32 s54, 135
  s_cbranch_scc1 L_sk_33
  s_waitcnt vmcnt(4)
  s_cmpk_le_i32 s58, 135
  s_cbranch_scc1 L_sk_33
  s_waitcnt vmcnt(3)
L_sk_33:
  s_and_b32 s50, s50, 31
  s_mul_i32 s45, s50, 49152
  s_add_u32 s50, s50, 1
  buffer_load_dwordx4 v[116:119], v1, s[36:39], s45 offen offset:0 nt
  v_mfma_f32_16x16x32_bf16 v[28:31], v[80:83], v[8:11], v[28:31]
  v_mfma_f32_16x16x32_bf16 v[32:35], v[84:87], v[8:11], v[32:35]
  v_mfma_f32_16x16x32_bf16 v[36:39], v[88:91], v[8:11], v[36:39]
  v_and_b32 v12, v59, v4
  v_and_b32 v13, v59, v5
  v_and_b32 v14, v59, v6
  v_and_b32 v15, v59, v7
  s_waitcnt vmcnt(6)
  s_cmpk_gt_i32 s54, 136
  s_cbranch_scc1 L_sk_34
  s_waitcnt vmcnt(4)
  s_cmpk_le_i32 s58, 136
  s_cbranch_scc1 L_sk_34
  s_waitcnt vmcnt(3)
L_sk_34:
  buffer_load_dwordx4 v[120:123], v1, s[36:39], s45 offen offset:128 nt
  s_waitcnt vmcnt(6)
  s_cmpk_gt_i32 s54, 137
  s_cbranch_scc1 L_sk_35
  s_waitcnt vmcnt(4)
  s_cmpk_le_i32 s58, 137
  s_cbranch_scc1 L_sk_35
  s_waitcnt vmcnt(3)
L_sk_35:
  buffer_load_dwordx4 v[124:127], v1, s[36:39], s45 offen offset:256 nt
  s_waitcnt lgkmcnt(0)
  v_readfirstlane_b32 s54, v252
  v_readfirstlane_b32 s58, v253
  v_mov_b32 v251, 138
  ds_write_b32 v250, v251 offset:10912
  ds_read_b64 v[252:253], v250 offset:10832
  s_waitcnt vmcnt(6)
  s_cmpk_gt_i32 s54, 138
  s_cbranch_scc1 L_sk_36
  s_waitcnt vmcnt(4)
  s_cmpk_le_i32 s58, 138
  s_cbranch_scc1 L_sk_36
  s_waitcnt vmcnt(3)
L_sk_36:
  s_and_b32 s50, s50, 31
  s_mul_i32 s45, s50, 49152
  s_add_u32 s50, s50, 1
  buffer_load_dwordx4 v[128:131], v1, s[36:39], s45 offen offset:0 nt
  v_mfma_f32_16x16x32_bf16 v[28:31], v[92:95], v[12:15], v[28:31]
  v_mfma_f32_16x16x32_bf16 v[32:35], v[96:99], v[12:15], v[32:35]
  v_mfma_f32_16x16x32_bf16 v[36:39], v[100:103], v[12:15], v[36:39]
  v_and_b32 v8, v60, v4
  v_and_b32 v9, v60, v5
  v_and_b32 v10, v60, v6
  v_and_b32 v11, v60, v7
  s_waitcnt vmcnt(6)
  s_cmpk_gt_i32 s54, 139
  s_cbranch_scc1 L_sk_37
  s_waitcnt vmcnt(4)
  s_cmpk_le_i32 s58, 139
  s_cbranch_scc1 L_sk_37
  s_waitcnt vmcnt(3)
L_sk_37:
  buffer_load_dwordx4 v[132:135], v1, s[36:39], s45 offen offset:128 nt
  s_waitcnt vmcnt(6)
  s_cmpk_gt_i32 s54, 140
  s_cbranch_scc1 L_sk_38
  s_waitcnt vmcnt(4)
  s_cmpk_le_i32 s58, 140
  s_cbranch_scc1 L_sk_38
  s_waitcnt vmcnt(3)
L_sk_38:
  buffer_load_dwordx4 v[136:139], v1, s[36:39], s45 offen offset:256 nt
  s_mov_b64 exec, 1
  ds_add_u32 v248, v249 offset:10788
  s_mov_b64 exec, -1
  s_waitcnt lgkmcnt(0)
  v_readfirstlane_b32 s54, v252
  v_readfirstlane_b32 s58, v253
  v_mov_b32 v251, 141
  ds_write_b32 v250, v251 offset:10912
  ds_read_b64 v[252:253], v250 offset:10832
  s_waitcnt vmcnt(6)
  s_cmpk_gt_i32 s54, 141
  s_cbranch_scc1 L_sk_39
  s_waitcnt vmcnt(4)
  s_cmpk_le_i32 s58, 141
  s_cbranch_scc1 L_sk_39
  s_waitcnt vmcnt(3)
L_sk_39:
  s_and_b32 s50, s50, 31
  s_mul_i32 s45, s50, 49152
  s_add_u32 s50, s50, 1
  buffer_load_dwordx4 v[140:143], v1, s[36:39], s45 offen offset:0 nt
  v_mfma_f32_16x16x32_bf16 v[28:31], v[104:107], v[8:11], v[28:31]
  v_mfma_f32_16x16x32_bf16 v[32:35], v[108:111], v[8:11], v[32:35]
  v_mfma_f32_16x16x32_bf16 v[36:39], v[112:115], v[8:11], v[36:39]
  v_and_b32 v12, v61, v4
  v_and_b32 v13, v61, v5
  v_and_b32 v14, v61, v6
  v_and_b32 v15, v61, v7
  s_waitcnt vmcnt(6)
  s_cmpk_gt_i32 s54, 142
  s_cbranch_scc1 L_sk_40
  s_waitcnt vmcnt(4)
  s_cmpk_le_i32 s58, 142
  s_cbranch_scc1 L_sk_40
  s_waitcnt vmcnt(3)
L_sk_40:
  buffer_load_dwordx4 v[144:147], v1, s[36:39], s45 offen offset:128 nt
  s_waitcnt vmcnt(6)
  s_cmpk_gt_i32 s54, 143
  s_cbranch_scc1 L_sk_41
  s_waitcnt vmcnt(4)
  s_cmpk_le_i32 s58, 143
  s_cbranch_scc1 L_sk_41
  s_waitcnt vmcnt(3)
L_sk_41:
  buffer_load_dwordx4 v[148:151], v1, s[36:39], s45 offen offset:256 nt
  s_waitcnt lgkmcnt(0)
  v_readfirstlane_b32 s54, v252
  v_readfirstlane_b32 s58, v253
  v_mov_b32 v251, 144
  ds_write_b32 v250, v251 offset:10912
  ds_read_b64 v[252:253], v250 offset:10832
  ds_read_b64 v[254:255], v248 offset:10944
  s_memrealtime s[52:53]
  s_waitcnt vmcnt(6)
  s_cmpk_gt_i32 s54, 144
  s_cbranch_scc1 L_sk_42
  s_waitcnt vmcnt(4)
  s_cmpk_le_i32 s58, 144
  s_cbranch_scc1 L_sk_42
  s_waitcnt vmcnt(3)
L_sk_42:
  s_and_b32 s50, s50, 31
  s_mul_i32 s45, s50, 49152
  s_add_u32 s50, s50, 1
  buffer_load_dwordx4 v[152:155], v1, s[36:39], s45 offen offset:0 nt
  v_mfma_f32_16x16x32_bf16 v[28:31], v[116:119], v[12:15], v[28:31]
  v_mfma_f32_16x16x32_bf16 v[32:35], v[120:123], v[12:15], v[32:35]
  v_mfma_f32_16x16x32_bf16 v[36:39], v[124:127], v[12:15], v[36:39]
  v_and_b32 v8, v62, v4
  v_and_b32 v9, v62, v5
  v_and_b32 v10, v62, v6
  v_and_b32 v11, v62, v7
  s_waitcnt vmcnt(6)
  s_cmpk_gt_i32 s54, 145
  s_cbranch_scc1 L_sk_43
  s_waitcnt vmcnt(4)
  s_cmpk_le_i32 s58, 145
  s_cbranch_scc1 L_sk_43
  s_waitcnt vmcnt(3)
L_sk_43:
  buffer_load_dwordx4 v[156:159], v1, s[36:39], s45 offen offset:128 nt
  s_waitcnt vmcnt(6)
  s_cmpk_gt_i32 s54, 146
  s_cbranch_scc1 L_sk_44
  s_waitcnt vmcnt(4)
  s_cmpk_le_i32 s58, 146
  s_cbranch_scc1 L_sk_44
  s_waitcnt vmcnt(3)
L_sk_44:
  buffer_load_dwordx4 v[160:163], v1, s[36:39], s45 offen offset:256 nt
  s_waitcnt lgkmcnt(0)
  v_readfirstlane_b32 s54, v252
  v_readfirstlane_b32 s58, v253
  v_readfirstlane_b32 s51, v255
  v_readfirstlane_b32 s53, v254
  s_cmp_eq_u32 s51, 0
  s_cbranch_scc1 L_ns_45
  s_sub_u32 s67, 144, s67
  s_mul_i32 s51, s51, s67
  s_mov_b32 s67, s66
  s_add_u32 s53, s53, s51
  s_lshl_b32 s52, s52, 6
  s_sub_u32 s52, s52, s53
  s_cmpk_gt_i32 s52, 768
  s_cselect_b32 s54, 150, 0
  s_cselect_b32 s66, 2, 0
  s_cmpk_lt_i32 s52, -960
  s_cselect_b32 s58, 150, 0
  s_cselect_b32 s66, -1, s66
L_ns_45:
  v_mov_b32 v251, 147
  ds_write_b32 v250, v251 offset:10912
  ds_read_b64 v[252:253], v250 offset:10832
  ds_read_b64 v[254:255], v248 offset:10944
  s_memrealtime s[52:53]
  s_waitcnt vmcnt(6)
  s_cmpk_gt_i32 s54, 147
  s_cbranch_scc1 L_sk_46
  s_waitcnt vmcnt(4)
  s_cmpk_le_i32 s58, 147
  s_cbranch_scc1 L_sk_46
  s_waitcnt vmcnt(3)
L_sk_46:
  s_and_b32 s50, s50, 31
  s_mul_i32 s45, s50, 49152
  s_add_u32 s50, s50, 1
  buffer_load_dwordx4 v[164:167], v1, s[36:39], s45 offen offset:0 nt
  v_mfma_f32_16x16x32_bf16 v[28:31], v[128:131], v[8:11], v[28:31]
  v_mfma_f32_16x16x32_bf16 v[32:35], v[132:135], v[8:11], v[32:35]
  v_mfma_f32_16x16x32_bf16 v[36:39], v[136:139], v[8:11], v[36:39]
  v_and_b32 v12, v63, v4
  v_and_b32 v13, v63, v5
  v_and_b32 v14, v63, v6
  v_and_b32 v15, v63, v7
  s_waitcnt vmcnt(6)
  s_cmpk_gt_i32 s54, 148
  s_cbranch_scc1 L_sk_47
  s_waitcnt vmcnt(4)
  s_cmpk_le_i32 s58, 148
  s_cbranch_scc1 L_sk_47
  s_waitcnt vmcnt(3)
L_sk_47:
  buffer_load_dwordx4 v[168:171], v1, s[36:39], s45 offen offset:128 nt
  s_waitcnt vmcnt(6)
  s_cmpk_gt_i32 s54, 149
  s_cbranch_scc1 L_sk_48
  s_waitcnt vmcnt(4)
  s_cmpk_le_i32 s58, 149
  s_cbranch_scc1 L_sk_48
  s_waitcnt vmcnt(3)
L_sk_48:
  buffer_load_dwordx4 v[172:175], v1, s[36:39], s45 offen offset:256 nt
  s_waitcnt lgkmcnt(0)
  v_readfirstlane_b32 s54, v252
  v_readfirstlane_b32 s58, v253
  v_readfirstlane_b32 s51, v255
  v_readfirstlane_b32 s53, v254
  s_cmp_eq_u32 s51, 0
  s_cbranch_scc1 L_ns_49
  s_sub_u32 s67, 147, s67
  s_mul_i32 s51, s51, s67
  s_mov_b32 s67, s66
  s_add_u32 s53, s53, s51
  s_lshl_b32 s52, s52, 6
  s_sub_u32 s52, s52, s53
  s_cmpk_gt_i32 s52, 768
  s_cselect_b32 s54, 153, 0
  s_cselect_b32 s66, 2, 0
  s_cmpk_lt_i32 s52, -960
  s_cselect_b32 s58, 153, 0
  s_cselect_b32 s66, -1, s66
L_ns_49:
  v_mov_b32 v251, 150
  ds_write_b32 v250, v251 offset:10912
  ds_read_b64 v[252:253], v250 offset:10832
  ds_read_b64 v[254:255], v248 offset:10944
  s_memrealtime s[52:53]
  s_waitcnt vmcnt(6)
  s_cmpk_gt_i32 s54, 150
  s_cbranch_scc1 L_sk_50
  s_waitcnt vmcnt(4)
  s_cmpk_le_i32 s58, 150
  s_cbranch_scc1 L_sk_50
  s_waitcnt vmcnt(3)
L_sk_50:
  s_and_b32 s50, s50, 31
  s_mul_i32 s45, s50, 49152
  s_add_u32 s50, s50, 1
  buffer_load_dwordx4 v[176:179], v1, s[36:39], s45 offen offset:0 nt
  v_mfma_f32_16x16x32_bf16 v[28:31], v[140:143], v[12:15], v[28:31]
  v_mfma_f32_16x16x32_bf16 v[32:35], v[144:147], v[12:15], v[32:35]
  v_mfma_f32_16x16x32_bf16 v[36:39], v[148:151], v[12:15], v[36:39]
  v_and_b32 v8, v64, v4
  v_and_b32 v9, v64, v5
  v_and_b32 v10, v64, v6
  v_and_b32 v11, v64, v7
  s_waitcnt vmcnt(6)
  s_cmpk_gt_i32 s54, 151
  s_cbranch_scc1 L_sk_51
  s_waitcnt vmcnt(4)
  s_cmpk_le_i32 s58, 151
  s_cbranch_scc1 L_sk_51
  s_waitcnt vmcnt(3)
L_sk_51:
  buffer_load_dwordx4 v[180:183], v1, s[36:39], s45 offen offset:128 nt
  s_waitcnt vmcnt(6)
  s_cmpk_gt_i32 s54, 152
  s_cbranch_scc1 L_sk_52
  s_waitcnt vmcnt(4)
  s_cmpk_le_i32 s58, 152
  s_cbranch_scc1 L_sk_52
  s_waitcnt vmcnt(3)
L_sk_52:
  buffer_load_dwordx4 v[184:187], v1, s[36:39], s45 offen offset:256 nt
  s_waitcnt lgkmcnt(0)
  v_readfirstlane_b32 s54, v252
  v_readfirstlane_b32 s58, v253
  v_readfirstlane_b32 s51, v255
  v_readfirstlane_b32 s53, v254
  s_cmp_eq_u32 s51, 0
  s_cbranch_scc1 L_ns_53
  s_sub_u32 s67, 150, s67
  s_mul_i32 s51, s51, s67
  s_mov_b32 s67, s66
  s_add_u32 s53, s53, s51
  s_lshl_b32 s52, s52, 6
  s_sub_u32 s52, s52, s53
  s_cmpk_gt_i32 s52, 768
  s_cselect_b32 s54, 156, 0
  s_cselect_b32 s66, 2, 0
  s_cmpk_lt_i32 s52, -960
  s_cselect_b32 s58, 156, 0
  s_cselect_b32 s66, -1, s66
L_ns_53:
  v_mov_b32 v251, 153
  ds_write_b32 v250, v251 offset:10912
  ds_read_b64 v[252:253], v250 offset:10832
  ds_read_b64 v[254:255], v248 offset:10944
  s_memrealtime s[52:53]
  s_waitcnt vmcnt(6)
  s_cmpk_gt_i32 s54, 153
  s_cbranch_scc1 L_sk_54
  s_waitcnt vmcnt(4)
  s_cmpk_le_i32 s58, 153
  s_cbranch_scc1 L_sk_54
  s_waitcnt vmcnt(3)
L_sk_54:
  s_and_b32 s50, s50, 31
  s_mul_i32 s45, s50, 49152
  s_add_u32 s50, s50, 1
  buffer_load_dwordx4 v[188:191], v1, s[36:39], s45 offen offset:0 nt
  v_mfma_f32_16x16x32_bf16 v[28:31], v[152:155], v[8:11], v[28:31]
  v_mfma_f32_16x16x32_bf16 v[32:35], v[156:159], v[8:11], v[32:35]
  v_mfma_f32_16x16x32_bf16 v[36:39], v[160:163], v[8:11], v[36:39]
  v_and_b32 v12, v65, v4
  v_and_b32 v13, v65, v5
  v_and_b32 v14, v65, v6
  v_and_b32 v15, v65, v7
  s_waitcnt vmcnt(6)
  s_cmpk_gt_i32 s54, 154
  s_cbranch_scc1 L_sk_55
  s_waitcnt vmcnt(4)
  s_cmpk_le_i32 s58, 154
  s_cbranch_scc1 L_sk_55
  s_waitcnt vmcnt(3)
L_sk_55:
  buffer_load_dwordx4 v[192:195], v1, s[36:39], s45 offen offset:128 nt
  s_waitcnt vmcnt(6)
  s_cmpk_gt_i32 s54, 155
  s_cbranch_scc1 L_sk_56
  s_waitcnt vmcnt(4)
  s_cmpk_le_i32 s58, 155
  s_cbranch_scc1 L_sk_56
  s_waitcnt vmcnt(3)
L_sk_56:
  buffer_load_dwordx4 v[196:199], v1, s[36:39], s45 offen offset:256 nt
  s_waitcnt lgkmcnt(0)
  v_readfirstlane_b32 s54, v252
  v_readfirstlane_b32 s58, v253
  v_readfirstlane_b32 s51, v255
  v_readfirstlane_b32 s53, v254
  s_cmp_eq_u32 s51, 0
  s_cbranch_scc1 L_ns_57
  s_sub_u32 s67, 153, s67
  s_mul_i32 s51, s51, s67
  s_mov_b32 s67, s66
  s_add_u32 s53, s53, s51
  s_lshl_b32 s52, s52, 6
  s_sub_u32 s52, s52, s53
  s_cmpk_gt_i32 s52, 768
  s_cselect_b32 s54, 159, 0
  s_cselect_b32 s66, 2, 0
  s_cmpk_lt_i32 s52, -960
  s_cselect_b32 s58, 159, 0
  s_cselect_b32 s66, -1, s66
L_ns_57:
  v_mov_b32 v251, 156
  ds_write_b32 v250, v251 offset:10912
  ds_read_b64 v[252:253], v250 offset:10832
  ds_read_b64 v[254:255], v248 offset:10944
  s_memrealtime s[52:53]
  s_waitcnt vmcnt(6)
  s_cmpk_gt_i32 s54, 156
  s_cbranch_scc1 L_sk_58
  s_waitcnt vmcnt(4)
  s_cmpk_le_i32 s58, 156
  s_cbranch_scc1 L_sk_58
  s_waitcnt vmcnt(3)
L_sk_58:
  s_and_b32 s50, s50, 31
  s_mul_i32 s45, s50, 49152
  s_add_u32 s50, s50, 1
  buffer_load_dwordx4 v[200:203], v1, s[36:39], s45 offen offset:0 nt
  v_mfma_f32_16x16x32_bf16 v[28:31], v[164:167], v[12:15], v[28:31]
  v_mfma_f32_16x16x32_bf16 v[32:35], v[168:171], v[12:15], v[32:35]
  v_mfma_f32_16x16x32_bf16 v[36:39], v[172:175], v[12:15], v[36:39]
  v_and_b32 v8, v66, v4
  v_and_b32 v9, v66, v5
  v_and_b32 v10, v66, v6
  v_and_b32 v11, v66, v7
  s_waitcnt vmcnt(6)
  s_cmpk_gt_i32 s54, 157
  s_cbranch_scc1 L_sk_59
  s_waitcnt vmcnt(4)
  s_cmpk_le_i32 s58, 157
  s_cbranch_scc1 L_sk_59
  s_waitcnt vmcnt(3)
L_sk_59:
  buffer_load_dwordx4 v[204:207], v1, s[36:39], s45 offen offset:128 nt
  s_waitcnt vmcnt(6)
  s_cmpk_gt_i32 s54, 158
  s_cbranch_scc1 L_sk_60
  s_waitcnt vmcnt(4)
  s_cmpk_le_i32 s58, 158
  s_cbranch_scc1 L_sk_60
  s_waitcnt vmcnt(3)
L_sk_60:
  buffer_load_dwordx4 v[208:211], v1, s[36:39], s45 offen offset:256 nt
  s_waitcnt lgkmcnt(0)
  v_readfirstlane_b32 s54, v252
  v_readfirstlane_b32 s58, v253
  v_readfirstlane_b32 s51, v255
  v_readfirstlane_b32 s53, v254
  s_cmp_eq_u32 s51, 0
  s_cbranch_scc1 L_ns_61
  s_sub_u32 s67, 156, s67
  s_mul_i32 s51, s51, s67
  s_mov_b32 s67, s66
  s_add_u32 s53, s53, s51
  s_lshl_b32 s52, s52, 6
  s_sub_u32 s52, s52, s53
  s_cmpk_gt_i32 s52, 768
  s_cselect_b32 s54, 162, 0
  s_cselect_b32 s66, 2, 0
  s_cmpk_lt_i32 s52, -960
  s_cselect_b32 s58, 162, 0
  s_cselect_b32 s66, -1, s66
L_ns_61:
  v_mov_b32 v251, 159
  ds_write_b32 v250, v251 offset:10912
  ds_read_b64 v[252:253], v250 offset:10832
  ds_read_b64 v[254:255], v248 offset:10944
  s_memrealtime s[52:53]
  s_waitcnt vmcnt(6)
  s_cmpk_gt_i32 s54, 159
  s_cbranch_scc1 L_sk_62
  s_waitcnt vmcnt(4)
  s_cmpk_le_i32 s58, 159
  s_cbranch_scc1 L_sk_62
  s_waitcnt vmcnt(3)
L_sk_62:
  s_and_b32 s50, s50, 31
  s_mul_i32 s45, s50, 49152
  s_add_u32 s50, s50, 1
  buffer_load_dwordx4 v[212:215], v1, s[36:39], s45 offen offset:0 nt
  v_mfma_f32_16x16x32_bf16 v[28:31], v[176:179], v[8:11], v[28:31]
  v_mfma_f32_16x16x32_bf16 v[32:35], v[180:183], v[8:11], v[32:35]
  v_mfma_f32_16x16x32_bf16 v[36:39], v[184:187], v[8:11], v[36:39]
  v_and_b32 v12, v67, v4
  v_and_b32 v13, v67, v5
  v_and_b32 v14, v67, v6
  v_and_b32 v15, v67, v7
  s_waitcnt vmcnt(6)
  s_cmpk_gt_i32 s54, 160
  s_cbranch_scc1 L_sk_63
  s_waitcnt vmcnt(4)
  s_cmpk_le_i32 s58, 160
  s_cbranch_scc1 L_sk_63
  s_waitcnt vmcnt(3)
L_sk_63:
  buffer_load_dwordx4 v[216:219], v1, s[36:39], s45 offen offset:128 nt
  s_waitcnt vmcnt(6)
  s_cmpk_gt_i32 s54, 161
  s_cbranch_scc1 L_sk_64
  s_waitcnt vmcnt(4)
  s_cmpk_le_i32 s58, 161
  s_cbranch_scc1 L_sk_64
  s_waitcnt vmcnt(3)
L_sk_64:
  buffer_load_dwordx4 v[220:223], v1, s[36:39], s45 offen offset:256 nt
  s_waitcnt lgkmcnt(0)
  v_readfirstlane_b32 s54, v252
  v_readfirstlane_b32 s58, v253
  v_readfirstlane_b32 s51, v255
  v_readfirstlane_b32 s53, v254
  s_cmp_eq_u32 s51, 0
  s_cbranch_scc1 L_ns_65
  s_sub_u32 s67, 159, s67
  s_mul_i32 s51, s51, s67
  s_mov_b32 s67, s66
  s_add_u32 s53, s53, s51
  s_lshl_b32 s52, s52, 6
  s_sub_u32 s52, s52, s53
  s_cmpk_gt_i32 s52, 768
  s_cselect_b32 s54, 165, 0
  s_cselect_b32 s66, 2, 0
  s_cmpk_lt_i32 s52, -960
  s_cselect_b32 s58, 165, 0
  s_cselect_b32 s66, -1, s66
L_ns_65:
  v_mov_b32 v251, 162
  ds_write_b32 v250, v251 offset:10912
  ds_read_b64 v[252:253], v250 offset:10832
  ds_read_b64 v[254:255], v248 offset:10944
  s_memrealtime s[52:53]
  s_waitcnt vmcnt(6)
  s_cmpk_gt_i32 s54, 162
  s_cbranch_scc1 L_sk_66
  s_waitcnt vmcnt(4)
  s_cmpk_le_i32 s58, 162
  s_cbranch_scc1 L_sk_66
  s_waitcnt vmcnt(3)
L_sk_66:
  s_and_b32 s50, s50, 31
  s_mul_i32 s45, s50, 49152
  s_add_u32 s50, s50, 1
  buffer_load_dwordx4 v[224:227], v1, s[36:39], s45 offen offset:0 nt
  v_mfma_f32_16x16x32_bf16 v[28:31], v[188:191], v[12:15], v[28:31]
  v_mfma_f32_16x16x32_bf16 v[32:35], v[192:195], v[12:15], v[32:35]
  v_mfma_f32_16x16x32_bf16 v[36:39], v[196:199], v[12:15], v[36:39]
  v_and_b32 v8, v68, v4
  v_and_b32 v9, v68, v5
  v_and_b32 v10, v68, v6
  v_and_b32 v11, v68, v7
  s_waitcnt vmcnt(6)
  s_cmpk_gt_i32 s54, 163
  s_cbranch_scc1 L_sk_67
  s_waitcnt vmcnt(4)
  s_cmpk_le_i32 s58, 163
  s_cbranch_scc1 L_sk_67
  s_waitcnt vmcnt(3)
L_sk_67:
  buffer_load_dwordx4 v[228:231], v1, s[36:39], s45 offen offset:128 nt
  s_waitcnt vmcnt(6)
  s_cmpk_gt_i32 s54, 164
  s_cbranch_scc1 L_sk_68
  s_waitcnt vmcnt(4)
  s_cmpk_le_i32 s58, 164
  s_cbranch_scc1 L_sk_68
  s_waitcnt vmcnt(3)
L_sk_68:
  buffer_load_dwordx4 v[232:235], v1, s[36:39], s45 offen offset:256 nt
  s_waitcnt lgkmcnt(0)
  v_readfirstlane_b32 s54, v252
  v_readfirstlane_b32 s58, v253
  v_readfirstlane_b32 s51, v255
  v_readfirstlane_b32 s53, v254
  s_cmp_eq_u32 s51, 0
  s_cbranch_scc1 L_ns_69
  s_sub_u32 s67, 162, s67
  s_mul_i32 s51, s51, s67
  s_mov_b32 s67, s66
  s_add_u32 s53, s53, s51
  s_lshl_b32 s52, s52, 6
  s_sub_u32 s52, s52, s53
  s_cmpk_gt_i32 s52, 768
  s_cselect_b32 s54, 168, 0
  s_cselect_b32 s66, 2, 0
  s_cmpk_lt_i32 s52, -960
  s_cselect_b32 s58, 168, 0
  s_cselect_b32 s66, -1, s66
L_ns_69:
  v_mov_b32 v251, 165
  ds_write_b32 v250, v251 offset:10912
  ds_read_b64 v[252:253], v250 offset:10832
  ds_read_b64 v[254:255], v248 offset:10944
  s_memrealtime s[52:53]
  s_waitcnt vmcnt(6)
  s_cmpk_gt_i32 s54, 165
  s_cbranch_scc1 L_sk_70
  s_waitcnt vmcnt(4)
  s_cmpk_le_i32 s58, 165
  s_cbranch_scc1 L_sk_70
  s_waitcnt vmcnt(3)
L_sk_70:
  s_and_b32 s50, s50, 31
  s_mul_i32 s45, s50, 49152
  s_add_u32 s50, s50, 1
  buffer_load_dwordx4 v[236:239], v1, s[36:39], s45 offen offset:0 nt
  v_mfma_f32_16x16x32_bf16 v[28:31], v[200:203], v[8:11], v[28:31]
  v_mfma_f32_16x16x32_bf16 v[32:35], v[204:207], v[8:11], v[32:35]
  v_mfma_f32_16x16x32_bf16 v[36:39], v[208:211], v[8:11], v[36:39]
  v_and_b32 v12, v69, v4
  v_and_b32 v13, v69, v5
  v_and_b32 v14, v69, v6
  v_and_b32 v15, v69, v7
  s_waitcnt vmcnt(6)
  s_cmpk_gt_i32 s54, 166
  s_cbranch_scc1 L_sk_71
  s_waitcnt vmcnt(4)
  s_cmpk_le_i32 s58, 166
  s_cbranch_scc1 L_sk_71
  s_waitcnt vmcnt(3)
L_sk_71:
  buffer_load_dwordx4 v[240:243], v1, s[36:39], s45 offen offset:128 nt
  s_waitcnt vmcnt(6)
  s_cmpk_gt_i32 s54, 167
  s_cbranch_scc1 L_sk_72
  s_waitcnt vmcnt(4)
  s_cmpk_le_i32 s58, 167
  s_cbranch_scc1 L_sk_72
  s_waitcnt vmcnt(3)
L_sk_72:
  buffer_load_dwordx4 v[244:247], v1, s[36:39], s45 offen offset:256 nt
  s_waitcnt lgkmcnt(0)
  v_readfirstlane_b32 s54, v252
  v_readfirstlane_b32 s58, v253
  v_readfirstlane_b32 s51, v255
  v_readfirstlane_b32 s53, v254
  s_cmp_eq_u32 s51, 0
  s_cbranch_scc1 L_ns_73
  s_sub_u32 s67, 165, s67
  s_mul_i32 s51, s51, s67
  s_mov_b32 s67, s66
  s_add_u32 s53, s53, s51
  s_lshl_b32 s52, s52, 6
  s_sub_u32 s52, s52, s53
  s_cmpk_gt_i32 s52, 768
  s_cselect_b32 s54, 171, 0
  s_cselect_b32 s66, 2, 0
  s_cmpk_lt_i32 s52, -960
  s_cselect_b32 s58, 171, 0
  s_cselect_b32 s66, -1, s66
L_ns_73:
  v_mov_b32 v251, 168
  ds_write_b32 v250, v251 offset:10912
  ds_read_b64 v[252:253], v250 offset:10832
  ds_read_b64 v[254:255], v248 offset:10944
  s_memrealtime s[52:53]
  s_waitcnt vmcnt(6)
  s_cmpk_gt_i32 s54, 168
  s_cbranch_scc1 L_sk_74
  s_waitcnt vmcnt(4)
  s_cmpk_le_i32 s58, 168
  s_cbranch_scc1 L_sk_74
  s_waitcnt vmcnt(3)
L_sk_74:
  s_and_b32 s50, s50, 31
  s_mul_i32 s45, s50, 49152
  s_add_u32 s50, s50, 1
  buffer_load_dwordx4 v[80:83], v1, s[36:39], s45 offen offset:0 nt
  v_mfma_f32_16x16x32_bf16 v[28:31], v[212:215], v[12:15], v[28:31]
  v_mfma_f32_16x16x32_bf16 v[32:35], v[216:219], v[12:15], v[32:35]
  v_mfma_f32_16x16x32_bf16 v[36:39], v[220:223], v[12:15], v[36:39]
  v_and_b32 v8, v70, v4
  v_and_b32 v9, v70, v5
  v_and_b32 v10, v70, v6
  v_and_b32 v11, v70, v7
  s_waitcnt vmcnt(6)
  s_cmpk_gt_i32 s54, 169
  s_cbranch_scc1 L_sk_75
  s_waitcnt vmcnt(4)
  s_cmpk_le_i32 s58, 169
  s_cbranch_scc1 L_sk_75
  s_waitcnt vmcnt(3)
L_sk_75:
  buffer_load_dwordx4 v[84:87], v1, s[36:39], s45 offen offset:128 nt
  s_waitcnt vmcnt(6)
  s_cmpk_gt_i32 s54, 170
  s_cbranch_scc1 L_sk_76
  s_waitcnt vmcnt(4)
  s_cmpk_le_i32 s58, 170
  s_cbranch_scc1 L_sk_76
  s_waitcnt vmcnt(3)
L_sk_76:
  buffer_load_dwordx4 v[88:91], v1, s[36:39], s45 offen offset:256 nt
  s_waitcnt lgkmcnt(0)
  v_readfirstlane_b32 s54, v252
  v_readfirstlane_b32 s58, v253
  v_readfirstlane_b32 s51, v255
  v_readfirstlane_b32 s53, v254
  s_cmp_eq_u32 s51, 0
  s_cbranch_scc1 L_ns_77
  s_sub_u32 s67, 168, s67
  s_mul_i32 s51, s51, s67
  s_mov_b32 s67, s66
  s_add_u32 s53, s53, s51
  s_lshl_b32 s52, s52, 6
  s_sub_u32 s52, s52, s53
  s_cmpk_gt_i32 s52, 768
  s_cselect_b32 s54, 174, 0
  s_cselect_b32 s66, 2, 0
  s_cmpk_lt_i32 s52, -960
  s_cselect_b32 s58, 174, 0
  s_cselect_b32 s66, -1, s66
L_ns_77:
  v_mov_b32 v251, 171
  ds_write_b32 v250, v251 offset:10912
  ds_read_b64 v[252:253], v250 offset:10832
  ds_read_b64 v[254:255], v248 offset:10944
  s_memrealtime s[52:53]
  s_waitcnt vmcnt(6)
  s_cmpk_gt_i32 s54, 171
  s_cbranch_scc1 L_sk_78
  s_waitcnt vmcnt(4)
  s_cmpk_le_i32 s58, 171
  s_cbranch_scc1 L_sk_78
  s_waitcnt vmcnt(3)
L_sk_78:
  s_and_b32 s50, s50, 31
  s_mul_i32 s45, s50, 49152
  s_add_u32 s50, s50, 1
  buffer_load_dwordx4 v[92:95], v1, s[36:39], s45 offen offset:0 nt
  v_mfma_f32_16x16x32_bf16 v[28:31], v[224:227], v[8:11], v[28:31]
  v_mfma_f32_16x16x32_bf16 v[32:35], v[228:231], v[8:11], v[32:35]
  v_mfma_f32_16x16x32_bf16 v[36:39], v[232:235], v[8:11], v[36:39]
  v_and_b32 v12, v71, v4
  v_and_b32 v13, v71, v5
  v_and_b32 v14, v71, v6
  v_and_b32 v15, v71, v7
  s_waitcnt vmcnt(6)
  s_cmpk_gt_i32 s54, 172
  s_cbranch_scc1 L_sk_79
  s_waitcnt vmcnt(4)
  s_cmpk_le_i32 s58, 172
  s_cbranch_scc1 L_sk_79
  s_waitcnt vmcnt(3)
L_sk_79:
  buffer_load_dwordx4 v[96:99], v1, s[36:39], s45 offen offset:128 nt
  s_waitcnt vmcnt(6)
  s_cmpk_gt_i32 s54, 173
  s_cbranch_scc1 L_sk_80
  s_waitcnt vmcnt(4)
  s_cmpk_le_i32 s58, 173
  s_cbranch_scc1 L_sk_80
  s_waitcnt vmcnt(3)
L_sk_80:
  buffer_load_dwordx4 v[100:103], v1, s[36:39], s45 offen offset:256 nt
  s_waitcnt lgkmcnt(0)
  v_readfirstlane_b32 s54, v252
  v_readfirstlane_b32 s58, v253
  v_readfirstlane_b32 s51, v255
  v_readfirstlane_b32 s53, v254
  s_cmp_eq_u32 s51, 0
  s_cbranch_scc1 L_ns_81
  s_sub_u32 s67, 171, s67
  s_mul_i32 s51, s51, s67
  s_mov_b32 s67, s66
  s_add_u32 s53, s53, s51
  s_lshl_b32 s52, s52, 6
  s_sub_u32 s52, s52, s53
  s_cmpk_gt_i32 s52, 768
  s_cselect_b32 s54, 177, 0
  s_cselect_b32 s66, 2, 0
  s_cmpk_lt_i32 s52, -960
  s_cselect_b32 s58, 177, 0
  s_cselect_b32 s66, -1, s66
L_ns_81:
  v_mov_b32 v251, 174
  ds_write_b32 v250, v251 offset:10912
  ds_read_b64 v[252:253], v250 offset:10832
  ds_read_b64 v[254:255], v248 offset:10944
  s_memrealtime s[52:53]
  s_waitcnt vmcnt(6)
  s_cmpk_gt_i32 s54, 174
  s_cbranch_scc1 L_sk_82
  s_waitcnt vmcnt(4)
  s_cmpk_le_i32 s58, 174
  s_cbranch_scc1 L_sk_82
  s_waitcnt vmcnt(3)
L_sk_82:
  s_and_b32 s50, s50, 31
  s_mul_i32 s45, s50, 49152
  s_add_u32 s50, s50, 1
  buffer_load_dwordx4 v[104:107], v1, s[36:39], s45 offen offset:0 nt
  v_mfma_f32_16x16x32_bf16 v[28:31], v[236:239], v[12:15], v[28:31]
  v_mfma_f32_16x16x32_bf16 v[32:35], v[240:243], v[12:15], v[32:35]
  v_mfma_f32_16x16x32_bf16 v[36:39], v[244:247], v[12:15], v[36:39]
  v_and_b32 v8, v72, v4
  v_and_b32 v9, v72, v5
  v_and_b32 v10, v72, v6
  v_and_b32 v11, v72, v7
  s_waitcnt vmcnt(6)
  s_cmpk_gt_i32 s54, 175
  s_cbranch_scc1 L_sk_83
  s_waitcnt vmcnt(4)
  s_cmpk_le_i32 s58, 175
  s_cbranch_scc1 L_sk_83
  s_waitcnt vmcnt(3)
L_sk_83:
  buffer_load_dwordx4 v[108:111], v1, s[36:39], s45 offen offset:128 nt
  s_waitcnt vmcnt(6)
  s_cmpk_gt_i32 s54, 176
  s_cbranch_scc1 L_sk_84
  s_waitcnt vmcnt(4)
  s_cmpk_le_i32 s58, 176
  s_cbranch_scc1 L_sk_84
  s_waitcnt vmcnt(3)
L_sk_84:
  buffer_load_dwordx4 v[112:115], v1, s[36:39], s45 offen offset:256 nt
  s_waitcnt lgkmcnt(0)
  v_readfirstlane_b32 s54, v252
  v_readfirstlane_b32 s58, v253
  v_readfirstlane_b32 s51, v255
  v_readfirstlane_b32 s53, v254
  s_cmp_eq_u32 s51, 0
  s_cbranch_scc1 L_ns_85
  s_sub_u32 s67, 174, s67
  s_mul_i32 s51, s51, s67
  s_mov_b32 s67, s66
  s_add_u32 s53, s53, s51
  s_lshl_b32 s52, s52, 6
  s_sub_u32 s52, s52, s53
  s_cmpk_gt_i32 s52, 768
  s_cselect_b32 s54, 180, 0
  s_cselect_b32 s66, 2, 0
  s_cmpk_lt_i32 s52, -960
  s_cselect_b32 s58, 180, 0
  s_cselect_b32 s66, -1, s66
L_ns_85:
  v_mov_b32 v251, 177
  ds_write_b32 v250, v251 offset:10912
  ds_read_b64 v[252:253], v250 offset:10832
  ds_read_b64 v[254:255], v248 offset:10944
  s_memrealtime s[52:53]
  s_waitcnt vmcnt(6)
  s_cmpk_gt_i32 s54, 177
  s_cbranch_scc1 L_sk_86
  s_waitcnt vmcnt(4)
  s_cmpk_le_i32 s58, 177
  s_cbranch_scc1 L_sk_86
  s_waitcnt vmcnt(3)
L_sk_86:
  s_and_b32 s50, s50, 31
  s_mul_i32 s45, s50, 49152
  s_add_u32 s50, s50, 1
  buffer_load_dwordx4 v[116:119], v1, s[36:39], s45 offen offset:0 nt
  v_mfma_f32_16x16x32_bf16 v[28:31], v[80:83], v[8:11], v[28:31]
  v_mfma_f32_16x16x32_bf16 v[32:35], v[84:87], v[8:11], v[32:35]
  v_mfma_f32_16x16x32_bf16 v[36:39], v[88:91], v[8:11], v[36:39]
  v_and_b32 v12, v73, v4
  v_and_b32 v13, v73, v5
  v_and_b32 v14, v73, v6
  v_and_b32 v15, v73, v7
  s_waitcnt vmcnt(6)
  s_cmpk_gt_i32 s54, 178
  s_cbranch_scc1 L_sk_87
  s_waitcnt vmcnt(4)
  s_cmpk_le_i32 s58, 178
  s_cbranch_scc1 L_sk_87
  s_waitcnt vmcnt(3)
L_sk_87:
  buffer_load_dwordx4 v[120:123], v1, s[36:39], s45 offen offset:128 nt
  s_waitcnt vmcnt(6)
  s_cmpk_gt_i32 s54, 179
  s_cbranch_scc1 L_sk_88
  s_waitcnt vmcnt(4)
  s_cmpk_le_i32 s58, 179
  s_cbranch_scc1 L_sk_88
  s_waitcnt vmcnt(3)
L_sk_88:
  buffer_load_dwordx4 v[124:127], v1, s[36:39], s45 offen offset:256 nt
  s_waitcnt lgkmcnt(0)
  v_readfirstlane_b32 s54, v252
  v_readfirstlane_b32 s58, v253
  v_readfirstlane_b32 s51, v255
  v_readfirstlane_b32 s53, v254
  s_cmp_eq_u32 s51, 0
  s_cbranch_scc1 L_ns_89
  s_sub_u32 s67, 177, s67
  s_mul_i32 s51, s51, s67
  s_mov_b32 s67, s66
  s_add_u32 s53, s53, s51
  s_lshl_b32 s52, s52, 6
  s_sub_u32 s52, s52, s53
  s_cmpk_gt_i32 s52, 768
  s_cselect_b32 s54, 183, 0
  s_cselect_b32 s66, 2, 0
  s_cmpk_lt_i32 s52, -960
  s_cselect_b32 s58, 183, 0
  s_cselect_b32 s66, -1, s66
L_ns_89:
  v_mov_b32 v251, 180
  ds_write_b32 v250, v251 offset:10912
  ds_read_b64 v[252:253], v250 offset:10832
  ds_read_b64 v[254:255], v248 offset:10944
  s_memrealtime s[52:53]
  s_waitcnt vmcnt(6)
  s_cmpk_gt_i32 s54, 180
  s_cbranch_scc1 L_sk_90
  s_waitcnt vmcnt(4)
  s_cmpk_le_i32 s58, 180
  s_cbranch_scc1 L_sk_90
  s_waitcnt vmcnt(3)
L_sk_90:
  s_and_b32 s50, s50, 31
  s_mul_i32 s45, s50, 49152
  s_add_u32 s50, s50, 1
  buffer_load_dwordx4 v[128:131], v1, s[36:39], s45 offen offset:0 nt
  v_mfma_f32_16x16x32_bf16 v[28:31], v[92:95], v[12:15], v[28:31]
  v_mfma_f32_16x16x32_bf16 v[32:35], v[96:99], v[12:15], v[32:35]
  v_mfma_f32_16x16x32_bf16 v[36:39], v[100:103], v[12:15], v[36:39]
  v_and_b32 v8, v74, v4
  v_and_b32 v9, v74, v5
  v_and_b32 v10, v74, v6
  v_and_b32 v11, v74, v7
  s_waitcnt vmcnt(6)
  s_cmpk_gt_i32 s54, 181
  s_cbranch_scc1 L_sk_91
  s_waitcnt vmcnt(4)
  s_cmpk_le_i32 s58, 181
  s_cbranch_scc1 L_sk_91
  s_waitcnt vmcnt(3)
L_sk_91:
  buffer_load_dwordx4 v[132:135], v1, s[36:39], s45 offen offset:128 nt
  s_waitcnt vmcnt(6)
  s_cmpk_gt_i32 s54, 182
  s_cbranch_scc1 L_sk_92
  s_waitcnt vmcnt(4)
  s_cmpk_le_i32 s58, 182
  s_cbranch_scc1 L_sk_92
  s_waitcnt vmcnt(3)
L_sk_92:
  buffer_load_dwordx4 v[136:139], v1, s[36:39], s45 offen offset:256 nt
  s_waitcnt lgkmcnt(0)
  v_readfirstlane_b32 s54, v252
  v_readfirstlane_b32 s58, v253
  v_readfirstlane_b32 s51, v255
  v_readfirstlane_b32 s53, v254
  s_cmp_eq_u32 s51, 0
  s_cbranch_scc1 L_ns_93
  s_sub_u32 s67, 180, s67
  s_mul_i32 s51, s51, s67
  s_mov_b32 s67, s66
  s_add_u32 s53, s53, s51
  s_lshl_b32 s52, s52, 6
  s_sub_u32 s52, s52, s53
  s_cmpk_gt_i32 s52, 768
  s_cselect_b32 s54, 186, 0
  s_cselect_b32 s66, 2, 0
  s_cmpk_lt_i32 s52, -960
  s_cselect_b32 s58, 186, 0
  s_cselect_b32 s66, -1, s66
L_ns_93:
  v_mov_b32 v251, 183
  ds_write_b32 v250, v251 offset:10912
  ds_read_b64 v[252:253], v250 offset:10832
  ds_read_b64 v[254:255], v248 offset:10944
  s_memrealtime s[52:53]
  s_waitcnt vmcnt(6)
  s_cmpk_gt_i32 s54, 183
  s_cbranch_scc1 L_sk_94
  s_waitcnt vmcnt(4)
  s_cmpk_le_i32 s58, 183
  s_cbranch_scc1 L_sk_94
  s_waitcnt vmcnt(3)
L_sk_94:
  s_and_b32 s50, s50, 31
  s_mul_i32 s45, s50, 49152
  s_add_u32 s50, s50, 1
  buffer_load_dwordx4 v[140:143], v1, s[36:39], s45 offen offset:0 nt
  v_mfma_f32_16x16x32_bf16 v[28:31], v[104:107], v[8:11], v[28:31]
  v_mfma_f32_16x16x32_bf16 v[32:35], v[108:111], v[8:11], v[32:35]
  v_mfma_f32_16x16x32_bf16 v[36:39], v[112:115], v[8:11], v[36:39]
  v_and_b32 v12, v75, v4
  v_and_b32 v13, v75, v5
  v_and_b32 v14, v75, v6
  v_and_b32 v15, v75, v7
  s_mov_b32 s62, 5747126
L_lw_95:
  ds_read_b32 v40, v248 offset:10760
  s_waitcnt lgkmcnt(0)
  v_readfirstlane_b32 s63, v40
  s_cmp_ge_u32 s63, 1
  s_cbranch_scc1 L_lok_96
  s_sleep 1
  s_sub_u32 s62, s62, 1
  s_cmp_lg_u32 s62, 0
  s_cbranch_scc1 L_lw_95
L_lok_96:
  ds_read_b64 v[16:17], v47 offset:10816
  s_waitcnt vmcnt(6)
  s_cmpk_gt_i32 s54, 184
  s_cbranch_scc1 L_sk_97
  s_waitcnt vmcnt(4)
  s_cmpk_le_i32 s58, 184
  s_cbranch_scc1 L_sk_97
  s_waitcnt vmcnt(3)
L_sk_97:
  buffer_load_dwordx4 v[144:147], v1, s[36:39], s45 offen offset:128 nt
  s_waitcnt vmcnt(6)
  s_cmpk_gt_i32 s54, 185
  s_cbranch_scc1 L_sk_98
  s_waitcnt vmcnt(4)
  s_cmpk_le_i32 s58, 185
  s_cbranch_scc1 L_sk_98
  s_waitcnt vmcnt(3)
L_sk_98:
  buffer_load_dwordx4 v[148:151], v1, s[36:39], s45 offen offset:256 nt
  s_waitcnt lgkmcnt(0)
  v_readfirstlane_b32 s54, v252
  v_readfirstlane_b32 s58, v253
  v_readfirstlane_b32 s51, v255
  v_readfirstlane_b32 s53, v254
  s_cmp_eq_u32 s51, 0
  s_cbranch_scc1 L_ns_99
  s_sub_u32 s67, 183, s67
  s_mul_i32 s51, s51, s67
  s_mov_b32 s67, s66
  s_add_u32 s53, s53, s51
  s_lshl_b32 s52, s52, 6
  s_sub_u32 s52, s52, s53
  s_cmpk_gt_i32 s52, 768
  s_cselect_b32 s54, 189, 0
  s_cselect_b32 s66, 2, 0
  s_cmpk_lt_i32 s52, -960
  s_cselect_b32 s58, 189, 0
  s_cselect_b32 s66, -1, s66
L_ns_99:
  v_mov_b32 v251, 186
  ds_write_b32 v250, v251 offset:10912
  ds_read_b64 v[252:253], v250 offset:10832
  ds_read_b64 v[254:255], v248 offset:10944
  s_memrealtime s[52:53]
  s_waitcnt vmcnt(6)
  s_cmpk_gt_i32 s54, 186
  s_cbranch_scc1 L_sk_100
  s_waitcnt vmcnt(4)
  s_cmpk_le_i32 s58, 186
  s_cbranch_scc1 L_sk_100
  s_waitcnt vmcnt(3)
L_sk_100:
  s_and_b32 s50, s50, 31
  s_mul_i32 s45, s50, 49152
  s_add_u32 s50, s50, 1
  buffer_load_dwordx4 v[152:155], v1, s[36:39], s45 offen offset:0 nt
  v_mfma_f32_16x16x32_bf16 v[28:31], v[116:119], v[12:15], v[28:31]
  v_mfma_f32_16x16x32_bf16 v[32:35], v[120:123], v[12:15], v[32:35]
  v_mfma_f32_16x16x32_bf16 v[36:39], v[124:127], v[12:15], v[36:39]
  v_and_b32 v8, v76, v4
  v_and_b32 v9, v76, v5
  v_and_b32 v10, v76, v6
  v_and_b32 v11, v76, v7
  s_waitcnt vmcnt(6)
  s_cmpk_gt_i32 s54, 187
  s_cbranch_scc1 L_sk_101
  s_waitcnt vmcnt(4)
  s_cmpk_le_i32 s58, 187
  s_cbranch_scc1 L_sk_101
  s_waitcnt vmcnt(3)
L_sk_101:
  buffer_load_dwordx4 v[156:159], v1, s[36:39], s45 offen offset:128 nt
  s_waitcnt vmcnt(6)
  s_cmpk_gt_i32 s54, 188
  s_cbranch_scc1 L_sk_102
  s_waitcnt vmcnt(4)
  s_cmpk_le_i32 s58, 188
  s_cbranch_scc1 L_sk_102
  s_waitcnt vmcnt(3)
L_sk_102:
  buffer_load_dwordx4 v[160:163], v1, s[36:39], s45 offen offset:256 nt
  s_waitcnt lgkmcnt(0)
  v_readfirstlane_b32 s54, v252
  v_readfirstlane_b32 s58, v253
  v_readfirstlane_b32 s51, v255
  v_readfirstlane_b32 s53, v254
  s_cmp_eq_u32 s51, 0
  s_cbranch_scc1 L_ns_103
  s_sub_u32 s67, 186, s67
  s_mul_i32 s51, s51, s67
  s_mov_b32 s67, s66
  s_add_u32 s53, s53, s51
  s_lshl_b32 s52, s52, 6
  s_sub_u32 s52, s52, s53
  s_cmpk_gt_i32 s52, 768
  s_cselect_b32 s54, 192, 0
  s_cselect_b32 s66, 2, 0
  s_cmpk_lt_i32 s52, -960
  s_cselect_b32 s58, 192, 0
  s_cselect_b32 s66, -1, s66
L_ns_103:
  s_waitcnt vmcnt(6)
  s_cmpk_gt_i32 s54, 189
  s_cbranch_scc1 L_sk_104
  s_waitcnt vmcnt(4)
  s_cmpk_le_i32 s58, 189
  s_cbranch_scc1 L_sk_104
  s_waitcnt vmcnt(3)
L_sk_104:
  s_and_b32 s50, s50, 31
  s_mul_i32 s45, s50, 49152
  s_add_u32 s50, s50, 1
  buffer_load_dwordx4 v[164:167], v1, s[36:39], s45 offen offset:0 nt
  v_mfma_f32_16x16x32_bf16 v[28:31], v[128:131], v[8:11], v[28:31]
  v_mfma_f32_16x16x32_bf16 v[32:35], v[132:135], v[8:11], v[32:35]
  v_mfma_f32_16x16x32_bf16 v[36:39], v[136:139], v[8:11], v[36:39]
  v_and_b32 v12, v77, v4
  v_and_b32 v13, v77, v5
  v_and_b32 v14, v77, v6
  v_and_b32 v15, v77, v7
  s_waitcnt vmcnt(6)
  s_cmpk_gt_i32 s54, 190
  s_cbranch_scc1 L_sk_105
  s_waitcnt vmcnt(4)
  s_cmpk_le_i32 s58, 190
  s_cbranch_scc1 L_sk_105
  s_waitcnt vmcnt(3)
L_sk_105:
  buffer_load_dwordx4 v[168:171], v1, s[36:39], s45 offen offset:128 nt
  s_waitcnt vmcnt(6)
  s_cmpk_gt_i32 s54, 191
  s_cbranch_scc1 L_sk_106
  s_waitcnt vmcnt(4)
  s_cmpk_le_i32 s58, 191
  s_cbranch_scc1 L_sk_106
  s_waitcnt vmcnt(3)
L_sk_106:
  buffer_load_dwordx4 v[172:175], v1, s[36:39], s45 offen offset:256 nt
  s_mov_b64 exec, 1
  ds_add_u32 v248, v249 offset:10772
  s_mov_b64 exec, -1
  s_waitcnt vmcnt(6)
  v_mfma_f32_16x16x32_bf16 v[28:31], v[140:143], v[12:15], v[28:31]
  v_mfma_f32_16x16x32_bf16 v[32:35], v[144:147], v[12:15], v[32:35]
  v_mfma_f32_16x16x32_bf16 v[36:39], v[148:151], v[12:15], v[36:39]
  v_and_b32 v8, v78, v4
  v_and_b32 v9, v78, v5
  v_and_b32 v10, v78, v6
  v_and_b32 v11, v78, v7
  s_waitcnt vmcnt(3)
  s_nop 0
  v_mfma_f32_16x16x32_bf16 v[28:31], v[152:155], v[8:11], v[28:31]
  v_mfma_f32_16x16x32_bf16 v[32:35], v[156:159], v[8:11], v[32:35]
  v_mfma_f32_16x16x32_bf16 v[36:39], v[160:163], v[8:11], v[36:39]
  v_and_b32 v12, v79, v4
  v_and_b32 v13, v79, v5
  v_and_b32 v14, v79, v6
  v_and_b32 v15, v79, v7
  s_waitcnt vmcnt(2)
  s_nop 0
  v_mfma_f32_16x16x32_bf16 v[28:31], v[164:167], v[12:15], v[28:31]
  s_waitcnt vmcnt(1)
  v_mfma_f32_16x16x32_bf16 v[32:35], v[168:171], v[12:15], v[32:35]
  s_waitcnt vmcnt(0)
  v_mfma_f32_16x16x32_bf16 v[36:39], v[172:175], v[12:15], v[36:39]
  s_mov_b32 exec_lo, 0x00ff00ff
  s_mov_b32 exec_hi, 0xff00ff00
  s_nop 1
  ds_write_b128 v3, v[28:31] offset:11008
  s_nop 0
  ds_write_b128 v3, v[32:35] offset:11264
  s_nop 0
  ds_write_b128 v3, v[36:39] offset:11520
  s_mov_b64 exec, 1
  ds_add_rtn_u32 v40, v248, v249 offset:10776
  s_mov_b64 exec, -1
  ds_read2_b64 v[48:51], v46 offset0:0 offset1:96
  ds_read2_b64 v[52:55], v46 offset0:32 offset1:128
  ds_read2_b64 v[56:59], v46 offset0:64 offset1:160
  ds_read2_b64 v[60:63], v45 offset0:0 offset1:96
  ds_read2_b64 v[64:67], v45 offset0:32 offset1:128
  ds_read2_b64 v[68:71], v45 offset0:64 offset1:160
  s_waitcnt lgkmcnt(6)
  v_readfirstlane_b32 s49, v40
  s_cmp_lg_u32 s49, 3
  s_cbranch_scc1 L_sdone
  s_waitcnt lgkmcnt(3)
  v_pk_add_f32 v[48:49], v[48:49], v[50:51]
  v_pk_add_f32 v[52:53], v[52:53], v[54:55]
  v_pk_add_f32 v[56:57], v[56:57], v[58:59]
  v_pk_mul_f32 v[72:73], v[48:49], v[16:17] op_sel_hi:[1,0]
  v_pk_mul_f32 v[74:75], v[52:53], v[16:17] op_sel_hi:[1,0]
  v_pk_mul_f32 v[76:77], v[56:57], v[16:17] op_sel_hi:[1,0]
  s_waitcnt lgkmcnt(0)
  v_pk_add_f32 v[60:61], v[60:61], v[62:63]
  v_pk_add_f32 v[64:65], v[64:65], v[66:67]
  v_pk_add_f32 v[68:69], v[68:69], v[70:71]
  v_pk_fma_f32 v[72:73], v[60:61], v[16:17], v[72:73] op_sel:[0,1,0] op_sel_hi:[1,1,1]
  v_pk_fma_f32 v[74:75], v[64:65], v[16:17], v[74:75] op_sel:[0,1,0] op_sel_hi:[1,1,1]
  v_pk_fma_f32 v[76:77], v[68:69], v[16:17], v[76:77] op_sel:[0,1,0] op_sel_hi:[1,1,1]
  v_mov_b32 v48, v72
  v_mov_b32 v49, v73
  v_mov_b32 v50, v74
  v_mov_b32 v51, v75
  v_mov_b32 v52, v76
  v_mov_b32 v53, v77
  v_permlane32_swap_b32 v48, v72
  v_permlane32_swap_b32 v49, v73
  v_permlane32_swap_b32 v50, v74
  v_permlane32_swap_b32 v51, v75
  v_permlane32_swap_b32 v52, v76
  v_permlane32_swap_b32 v53, v77
  v_pk_add_f32 v[72:73], v[72:73], v[48:49]
  v_pk_add_f32 v[74:75], v[74:75], v[50:51]
  v_pk_add_f32 v[76:77], v[76:77], v[52:53]
  v_cvt_pk_bf16_f32 v20, v72, v73
  v_cvt_pk_bf16_f32 v21, v74, v75
  v_cvt_pk_bf16_f32 v22, v76, v77
  s_mov_b32 exec_hi, 0
  buffer_store_dwordx4 v[20:23], v2, s[40:43], s48 offen sc1
  ds_write2_b32 v42, v20, v21 offset0:0 offset1:32
  ds_write_b32 v42, v22 offset:256
  s_mov_b32 exec_hi, -1
L_sdone:
  s_cmp_eq_u32 s55, 0
  s_cbranch_scc1 L_send
  s_mov_b32 s62, 200
L_op_107:
  ds_read_b32 v40, v248 offset:10796
  s_waitcnt lgkmcnt(0)
  v_readfirstlane_b32 s12, v40
  s_cmp_ge_u32 s12, 4
  s_cbranch_scc1 L_ook_108
  s_sleep 1
  s_sub_u32 s62, s62, 1
  s_cmp_lg_u32 s62, 0
  s_cbranch_scc1 L_op_107
L_ook_108:
  s_mov_b32 exec_lo, s59
  s_mov_b32 exec_hi, s60
  s_mov_b32 s62, 2941176
L_poll_109:
  buffer_load_dwordx4 v[80:83], v2, s[40:43], s56 offen sc1
  s_waitcnt vmcnt(0)
  v_cmp_ne_u32 vcc, s30, v83
  s_cbranch_vccz L_ok_110
  s_sub_u32 s62, s62, 1
  s_cmp_lg_u32 s62, 0
  s_cbranch_scc1 L_poll_109
L_ok_110:
  ds_write2_b32 v43, v80, v81 offset0:0 offset1:32
  ds_write_b32 v43, v82 offset:256
  s_waitcnt lgkmcnt(0)
  s_barrier
L_send:
  s_endpgm
L_helper2:
  v_lshrrev_b32 v2, 5, v0
  v_mul_u32_u24 v9, 2560, v2
  v_lshl_add_u32 v9, v3, 4, v9
  v_and_b32 v2, 1, v0
  v_lshlrev_b32 v2, 4, v2
  v_mov_b32 v3, 0xffff
  v_lshlrev_b32 v3, v2, v3
  v_bfe_u32 v2, v0, 1, 2
  v_cmp_eq_u32 vcc, 0, v2
  s_nop 1
  v_cndmask_b32 v4, 0, v3, vcc
  v_cmp_eq_u32 vcc, 1, v2
  s_nop 1
  v_cndmask_b32 v5, 0, v3, vcc
  v_cmp_eq_u32 vcc, 2, v2
  s_nop 1
  v_cndmask_b32 v6, 0, v3, vcc
  v_cmp_eq_u32 vcc, 3, v2
  s_nop 1
  v_cndmask_b32 v7, 0, v3, vcc
  s_mov_b32 s40, s22
  s_mov_b32 s41, s23
  s_mov_b32 s42, 1413120
  s_mov_b32 s43, 0x20000
  v_mov_b32 v15, 1
  s_waitcnt vmcnt(10)
  v_lshlrev_b32 v28, 16, v16
  v_and_b32 v29, 0xffff0000, v16
  v_lshlrev_b32 v30, 16, v17
  v_and_b32 v31, 0xffff0000, v17
  v_lshlrev_b32 v32, 16, v18
  v_and_b32 v33, 0xffff0000, v18
  v_lshlrev_b32 v34, 16, v19
  v_and_b32 v35, 0xffff0000, v19
  v_lshlrev_b32 v36, 16, v20
  v_and_b32 v37, 0xffff0000, v20
  v_lshlrev_b32 v38, 16, v21
  v_and_b32 v39, 0xffff0000, v21
  v_lshlrev_b32 v40, 16, v22
  v_and_b32 v41, 0xffff0000, v22
  v_lshlrev_b32 v42, 16, v23
  v_and_b32 v43, 0xffff0000, v23
  v_lshlrev_b32 v44, 16, v24
  v_and_b32 v45, 0xffff0000, v24
  v_lshlrev_b32 v46, 16, v25
  v_and_b32 v47, 0xffff0000, v25
  v_pk_add_f32 v[48:49], v[28:29], v[30:31]
  v_pk_add_f32 v[48:49], v[48:49], v[32:33]
  v_pk_add_f32 v[48:49], v[48:49], v[34:35]
  v_pk_add_f32 v[48:49], v[48:49], v[36:37]
  v_pk_add_f32 v[48:49], v[48:49], v[38:39]
  v_pk_add_f32 v[48:49], v[48:49], v[40:41]
  v_pk_add_f32 v[48:49], v[48:49], v[42:43]
  v_pk_add_f32 v[48:49], v[48:49], v[44:45]
  v_pk_add_f32 v[48:49], v[48:49], v[46:47]
  v_add_f32 v48, v48, v49
  s_nop 1
  v_add_f32_dpp v48, v48, v48 quad_perm:[1,0,3,2] row_mask:0xf bank_mask:0xf
  s_nop 1
  v_add_f32_dpp v48, v48, v48 quad_perm:[2,3,0,1] row_mask:0xf bank_mask:0xf
  s_nop 1
  v_add_f32_dpp v48, v48, v48 row_half_mirror row_mask:0xf bank_mask:0xf
  s_nop 1
  v_add_f32_dpp v48, v48, v48 row_mirror row_mask:0xf bank_mask:0xf
  v_mov_b32 v54, v48
  s_nop 1
  v_permlane16_swap_b32 v54, v48
  v_add_f32 v48, v54, v48
  s_mov_b32 s51, 0x3acccccd
  v_mul_f32 v48, s51, v48
  v_mov_b32 v50, 0
  v_mov_b32 v51, 0
  v_pk_add_f32 v[52:53], v[28:29], v[48:49] op_sel_hi:[1,0] neg_lo:[0,1] neg_hi:[0,1]
  v_pk_fma_f32 v[50:51], v[52:53], v[52:53], v[50:51]
  v_pk_add_f32 v[52:53], v[30:31], v[48:49] op_sel_hi:[1,0] neg_lo:[0,1] neg_hi:[0,1]
  v_pk_fma_f32 v[50:51], v[52:53], v[52:53], v[50:51]
  v_pk_add_f32 v[52:53], v[32:33], v[48:49] op_sel_hi:[1,0] neg_lo:[0,1] neg_hi:[0,1]
  v_pk_fma_f32 v[50:51], v[52:53], v[52:53], v[50:51]
  v_pk_add_f32 v[52:53], v[34:35], v[48:49] op_sel_hi:[1,0] neg_lo:[0,1] neg_hi:[0,1]
  v_pk_fma_f32 v[50:51], v[52:53], v[52:53], v[50:51]
  v_pk_add_f32 v[52:53], v[36:37], v[48:49] op_sel_hi:[1,0] neg_lo:[0,1] neg_hi:[0,1]
  v_pk_fma_f32 v[50:51], v[52:53], v[52:53], v[50:51]
  v_pk_add_f32 v[52:53], v[38:39], v[48:49] op_sel_hi:[1,0] neg_lo:[0,1] neg_hi:[0,1]
  v_pk_fma_f32 v[50:51], v[52:53], v[52:53], v[50:51]
  v_pk_add_f32 v[52:53], v[40:41], v[48:49] op_sel_hi:[1,0] neg_lo:[0,1] neg_hi:[0,1]
  v_pk_fma_f32 v[50:51], v[52:53], v[52:53], v[50:51]
  v_pk_add_f32 v[52:53], v[42:43], v[48:49] op_sel_hi:[1,0] neg_lo:[0,1] neg_hi:[0,1]
  v_pk_fma_f32 v[50:51], v[52:53], v[52:53], v[50:51]
  v_pk_add_f32 v[52:53], v[44:45], v[48:49] op_sel_hi:[1,0] neg_lo:[0,1] neg_hi:[0,1]
  v_pk_fma_f32 v[50:51], v[52:53], v[52:53], v[50:51]
  v_pk_add_f32 v[52:53], v[46:47], v[48:49] op_sel_hi:[1,0] neg_lo:[0,1] neg_hi:[0,1]
  v_pk_fma_f32 v[50:51], v[52:53], v[52:53], v[50:51]
  v_add_f32 v50, v50, v51
  s_nop 1
  v_add_f32_dpp v50, v50, v50 quad_perm:[1,0,3,2] row_mask:0xf bank_mask:0xf
  s_nop 1
  v_add_f32_dpp v50, v50, v50 quad_perm:[2,3,0,1] row_mask:0xf bank_mask:0xf
  s_nop 1
  v_add_f32_dpp v50, v50, v50 row_half_mirror row_mask:0xf bank_mask:0xf
  s_nop 1
  v_add_f32_dpp v50, v50, v50 row_mirror row_mask:0xf bank_mask:0xf
  v_mov_b32 v54, v50
  s_nop 1
  v_permlane16_swap_b32 v54, v50
  v_add_f32 v50, v54, v50
  v_mul_f32 v50, s51, v50
  v_cvt_pk_bf16_f32 v48, v48, v48
  v_and_b32 v48, 0xffff0000, v48
  v_cvt_pk_bf16_f32 v50, v50, v50
  v_and_b32 v50, 0xffff0000, v50
  v_add_f32 v50, 0x3727c5ac, v50
  v_cvt_pk_bf16_f32 v50, v50, v50
  v_and_b32 v50, 0xffff0000, v50
  v_sqrt_f32 v50, v50
  s_nop 0
  v_cvt_pk_bf16_f32 v50, v50, v50
  v_and_b32 v50, 0xffff0000, v50
  v_rcp_f32 v50, v50
  v_pk_add_f32 v[28:29], v[28:29], v[48:49] op_sel_hi:[1,0] neg_lo:[0,1] neg_hi:[0,1]
  v_cvt_pk_bf16_f32 v52, v28, v29
  v_lshlrev_b32 v28, 16, v52
  v_and_b32 v29, 0xffff0000, v52
  v_pk_mul_f32 v[28:29], v[28:29], v[50:51] op_sel_hi:[1,0]
  v_cvt_pk_bf16_f32 v28, v28, v28
  v_cvt_pk_bf16_f32 v29, v29, v29
  v_pk_add_f32 v[30:31], v[30:31], v[48:49] op_sel_hi:[1,0] neg_lo:[0,1] neg_hi:[0,1]
  v_cvt_pk_bf16_f32 v52, v30, v31
  v_lshlrev_b32 v30, 16, v52
  v_and_b32 v31, 0xffff0000, v52
  v_pk_mul_f32 v[30:31], v[30:31], v[50:51] op_sel_hi:[1,0]
  v_cvt_pk_bf16_f32 v30, v30, v30
  v_cvt_pk_bf16_f32 v31, v31, v31
  ds_write_b128 v9, v[28:31] offset:0
  v_pk_add_f32 v[32:33], v[32:33], v[48:49] op_sel_hi:[1,0] neg_lo:[0,1] neg_hi:[0,1]
  v_cvt_pk_bf16_f32 v52, v32, v33
  v_lshlrev_b32 v32, 16, v52
  v_and_b32 v33, 0xffff0000, v52
  v_pk_mul_f32 v[32:33], v[32:33], v[50:51] op_sel_hi:[1,0]
  v_cvt_pk_bf16_f32 v32, v32, v32
  v_cvt_pk_bf16_f32 v33, v33, v33
  v_pk_add_f32 v[34:35], v[34:35], v[48:49] op_sel_hi:[1,0] neg_lo:[0,1] neg_hi:[0,1]
  v_cvt_pk_bf16_f32 v52, v34, v35
  v_lshlrev_b32 v34, 16, v52
  v_and_b32 v35, 0xffff0000, v52
  v_pk_mul_f32 v[34:35], v[34:35], v[50:51] op_sel_hi:[1,0]
  v_cvt_pk_bf16_f32 v34, v34, v34
  v_cvt_pk_bf16_f32 v35, v35, v35
  ds_write_b128 v9, v[32:35] offset:512
  v_pk_add_f32 v[36:37], v[36:37], v[48:49] op_sel_hi:[1,0] neg_lo:[0,1] neg_hi:[0,1]
  v_cvt_pk_bf16_f32 v52, v36, v37
  v_lshlrev_b32 v36, 16, v52
  v_and_b32 v37, 0xffff0000, v52
  v_pk_mul_f32 v[36:37], v[36:37], v[50:51] op_sel_hi:[1,0]
  v_cvt_pk_bf16_f32 v36, v36, v36
  v_cvt_pk_bf16_f32 v37, v37, v37
  v_pk_add_f32 v[38:39], v[38:39], v[48:49] op_sel_hi:[1,0] neg_lo:[0,1] neg_hi:[0,1]
  v_cvt_pk_bf16_f32 v52, v38, v39
  v_lshlrev_b32 v38, 16, v52
  v_and_b32 v39, 0xffff0000, v52
  v_pk_mul_f32 v[38:39], v[38:39], v[50:51] op_sel_hi:[1,0]
  v_cvt_pk_bf16_f32 v38, v38, v38
  v_cvt_pk_bf16_f32 v39, v39, v39
  ds_write_b128 v9, v[36:39] offset:1024
  v_pk_add_f32 v[40:41], v[40:41], v[48:49] op_sel_hi:[1,0] neg_lo:[0,1] neg_hi:[0,1]
  v_cvt_pk_bf16_f32 v52, v40, v41
  v_lshlrev_b32 v40, 16, v52
  v_and_b32 v41, 0xffff0000, v52
  v_pk_mul_f32 v[40:41], v[40:41], v[50:51] op_sel_hi:[1,0]
  v_cvt_pk_bf16_f32 v40, v40, v40
  v_cvt_pk_bf16_f32 v41, v41, v41
  v_pk_add_f32 v[42:43], v[42:43], v[48:49] op_sel_hi:[1,0] neg_lo:[0,1] neg_hi:[0,1]
  v_cvt_pk_bf16_f32 v52, v42, v43
  v_lshlrev_b32 v42, 16, v52
  v_and_b32 v43, 0xffff0000, v52
  v_pk_mul_f32 v[42:43], v[42:43], v[50:51] op_sel_hi:[1,0]
  v_cvt_pk_bf16_f32 v42, v42, v42
  v_cvt_pk_bf16_f32 v43, v43, v43
  ds_write_b128 v9, v[40:43] offset:1536
  v_pk_add_f32 v[44:45], v[44:45], v[48:49] op_sel_hi:[1,0] neg_lo:[0,1] neg_hi:[0,1]
  v_cvt_pk_bf16_f32 v52, v44, v45
  v_lshlrev_b32 v44, 16, v52
  v_and_b32 v45, 0xffff0000, v52
  v_pk_mul_f32 v[44:45], v[44:45], v[50:51] op_sel_hi:[1,0]
  v_cvt_pk_bf16_f32 v44, v44, v44
  v_cvt_pk_bf16_f32 v45, v45, v45
  v_pk_add_f32 v[46:47], v[46:47], v[48:49] op_sel_hi:[1,0] neg_lo:[0,1] neg_hi:[0,1]
  v_cvt_pk_bf16_f32 v52, v46, v47
  v_lshlrev_b32 v46, 16, v52
  v_and_b32 v47, 0xffff0000, v52
  v_pk_mul_f32 v[46:47], v[46:47], v[50:51] op_sel_hi:[1,0]
  v_cvt_pk_bf16_f32 v46, v46, v46
  v_cvt_pk_bf16_f32 v47, v47, v47
  ds_write_b128 v9, v[44:47] offset:2048
  v_lshlrev_b32 v10, 2, v10
  ds_read_b64 v[104:105], v10 offset:0
  ds_read_b64 v[106:107], v10 offset:8
  ds_read_b64 v[108:109], v10 offset:16
  ds_read_b64 v[110:111], v10 offset:24
  ds_read_b64 v[112:113], v10 offset:32
  ds_read_b64 v[114:115], v10 offset:2560
  ds_read_b64 v[116:117], v10 offset:2568
  ds_read_b64 v[118:119], v10 offset:2576
  ds_read_b64 v[120:121], v10 offset:2584
  ds_read_b64 v[122:123], v10 offset:2592
  v_lshrrev_b32 v2, 4, v0
  v_lshrrev_b32 v3, 1, v2
  s_lshl_b32 s48, s24, 1
  v_add_u32 v3, s48, v3
  v_lshlrev_b32 v3, 8, v3
  v_and_b32 v2, 1, v2
  v_lshl_add_u32 v3, v2, 4, v3
  v_and_b32 v2, 7, v0
  v_lshl_add_u32 v3, v2, 5, v3
  v_bfe_u32 v2, v0, 4, 1
  v_and_b32 v8, 15, v0
  v_lshlrev_b32 v2, 11, v2
  v_lshl_add_u32 v2, v8, 4, v2
  v_lshlrev_b32 v8, 4, v0
  s_lshl_b32 s48, s2, 9
  s_add_u32 s48, s48, 4096
  s_waitcnt lgkmcnt(0)
  s_mul_i32 s30, s30, 0x19660d
  s_add_u32 s30, s30, 0x3c6ef35f
  s_mul_i32 s31, s31, 0x2c9277b5
  s_add_u32 s31, s31, 0xac564b05
  v_and_b32 v40, v104, v4
  v_and_b32 v41, v104, v5
  v_and_b32 v42, v104, v6
  v_and_b32 v43, v104, v7
  v_and_b32 v44, v114, v4
  v_and_b32 v45, v114, v5
  v_and_b32 v46, v114, v6
  v_and_b32 v47, v114, v7
  s_waitcnt vmcnt(9)
  v_mfma_f32_16x16x32_bf16 v[56:59], v[64:67], v[40:43], 0
  v_mfma_f32_16x16x32_bf16 v[60:63], v[64:67], v[44:47], 0
  v_and_b32 v48, v105, v4
  v_and_b32 v49, v105, v5
  v_and_b32 v50, v105, v6
  v_and_b32 v51, v105, v7
  v_and_b32 v52, v115, v4
  v_and_b32 v53, v115, v5
  v_and_b32 v54, v115, v6
  v_and_b32 v55, v115, v7
  s_waitcnt vmcnt(8)
  v_mfma_f32_16x16x32_bf16 v[56:59], v[68:71], v[48:51], v[56:59]
  v_mfma_f32_16x16x32_bf16 v[60:63], v[68:71], v[52:55], v[60:63]
  v_and_b32 v40, v106, v4
  v_and_b32 v41, v106, v5
  v_and_b32 v42, v106, v6
  v_and_b32 v43, v106, v7
  v_and_b32 v44, v116, v4
  v_and_b32 v45, v116, v5
  v_and_b32 v46, v116, v6
  v_and_b32 v47, v116, v7
  s_waitcnt vmcnt(7)
  v_mfma_f32_16x16x32_bf16 v[56:59], v[72:75], v[40:43], v[56:59]
  v_mfma_f32_16x16x32_bf16 v[60:63], v[72:75], v[44:47], v[60:63]
  v_and_b32 v48, v107, v4
  v_and_b32 v49, v107, v5
  v_and_b32 v50, v107, v6
  v_and_b32 v51, v107, v7
  v_and_b32 v52, v117, v4
  v_and_b32 v53, v117, v5
  v_and_b32 v54, v117, v6
  v_and_b32 v55, v117, v7
  s_waitcnt vmcnt(6)
  v_mfma_f32_16x16x32_bf16 v[56:59], v[76:79], v[48:51], v[56:59]
  v_mfma_f32_16x16x32_bf16 v[60:63], v[76:79], v[52:55], v[60:63]
  v_and_b32 v40, v108, v4
  v_and_b32 v41, v108, v5
  v_and_b32 v42, v108, v6
  v_and_b32 v43, v108, v7
  v_and_b32 v44, v118, v4
  v_and_b32 v45, v118, v5
  v_and_b32 v46, v118, v6
  v_and_b32 v47, v118, v7
  s_waitcnt vmcnt(5)
  v_mfma_f32_16x16x32_bf16 v[56:59], v[80:83], v[40:43], v[56:59]
  v_mfma_f32_16x16x32_bf16 v[60:63], v[80:83], v[44:47], v[60:63]
  v_and_b32 v48, v109, v4
  v_and_b32 v49, v109, v5
  v_and_b32 v50, v109, v6
  v_and_b32 v51, v109, v7
  v_and_b32 v52, v119, v4
  v_and_b32 v53, v119, v5
  v_and_b32 v54, v119, v6
  v_and_b32 v55, v119, v7
  s_waitcnt vmcnt(4)
  v_mfma_f32_16x16x32_bf16 v[56:59], v[84:87], v[48:51], v[56:59]
  v_mfma_f32_16x16x32_bf16 v[60:63], v[84:87], v[52:55], v[60:63]
  v_and_b32 v40, v110, v4
  v_and_b32 v41, v110, v5
  v_and_b32 v42, v110, v6
  v_and_b32 v43, v110, v7
  v_and_b32 v44, v120, v4
  v_and_b32 v45, v120, v5
  v_and_b32 v46, v120, v6
  v_and_b32 v47, v120, v7
  s_waitcnt vmcnt(3)
  v_mfma_f32_16x16x32_bf16 v[56:59], v[88:91], v[40:43], v[56:59]
  v_mfma_f32_16x16x32_bf16 v[60:63], v[88:91], v[44:47], v[60:63]
  v_and_b32 v48, v111, v4
  v_and_b32 v49, v111, v5
  v_and_b32 v50, v111, v6
  v_and_b32 v51, v111, v7
  v_and_b32 v52, v121, v4
  v_and_b32 v53, v121, v5
  v_and_b32 v54, v121, v6
  v_and_b32 v55, v121, v7
  s_waitcnt vmcnt(2)
  v_mfma_f32_16x16x32_bf16 v[56:59], v[92:95], v[48:51], v[56:59]
  v_mfma_f32_16x16x32_bf16 v[60:63], v[92:95], v[52:55], v[60:63]
  v_and_b32 v40, v112, v4
  v_and_b32 v41, v112, v5
  v_and_b32 v42, v112, v6
  v_and_b32 v43, v112, v7
  v_and_b32 v44, v122, v4
  v_and_b32 v45, v122, v5
  v_and_b32 v46, v122, v6
  v_and_b32 v47, v122, v7
  s_waitcnt vmcnt(1)
  v_mfma_f32_16x16x32_bf16 v[56:59], v[96:99], v[40:43], v[56:59]
  v_mfma_f32_16x16x32_bf16 v[60:63], v[96:99], v[44:47], v[60:63]
  v_and_b32 v48, v113, v4
  v_and_b32 v49, v113, v5
  v_and_b32 v50, v113, v6
  v_and_b32 v51, v113, v7
  v_and_b32 v52, v123, v4
  v_and_b32 v53, v123, v5
  v_and_b32 v54, v123, v6
  v_and_b32 v55, v123, v7
  s_waitcnt vmcnt(0)
  v_mfma_f32_16x16x32_bf16 v[56:59], v[100:103], v[48:51], v[56:59]
  v_mfma_f32_16x16x32_bf16 v[60:63], v[100:103], v[52:55], v[60:63]
  s_mov_b32 exec_lo, 0x00ff00ff
  s_mov_b32 exec_hi, 0xff00ff00
  s_nop 4
  ds_write_b128 v3, v[56:59] offset:5120
  ds_write_b128 v3, v[60:63] offset:7168
  s_mov_b64 exec, 1
  ds_add_rtn_u32 v14, v13, v15 offset:10752
  s_mov_b64 exec, -1
  ds_read_b128 v[64:67], v2 offset:5120
  ds_read_b128 v[68:71], v2 offset:5376
  ds_read_b128 v[72:75], v2 offset:5632
  ds_read_b128 v[76:79], v2 offset:5888
  ds_read_b128 v[80:83], v2 offset:6144
  ds_read_b128 v[84:87], v2 offset:6400
  ds_read_b128 v[88:91], v2 offset:6656
  ds_read_b128 v[92:95], v2 offset:6912
  s_waitcnt lgkmcnt(0)
  v_readfirstlane_b32 s49, v14
  s_cmp_lg_u32 s49, 3
  s_cbranch_scc1 L_x1_done
  v_pk_add_f32 v[64:65], v[64:65], v[68:69]
  v_pk_add_f32 v[66:67], v[66:67], v[70:71]
  v_pk_add_f32 v[72:73], v[72:73], v[76:77]
  v_pk_add_f32 v[74:75], v[74:75], v[78:79]
  v_pk_add_f32 v[80:81], v[80:81], v[84:85]
  v_pk_add_f32 v[82:83], v[82:83], v[86:87]
  v_pk_add_f32 v[88:89], v[88:89], v[92:93]
  v_pk_add_f32 v[90:91], v[90:91], v[94:95]
  v_pk_add_f32 v[64:65], v[64:65], v[72:73]
  v_pk_add_f32 v[66:67], v[66:67], v[74:75]
  v_pk_add_f32 v[80:81], v[80:81], v[88:89]
  v_pk_add_f32 v[82:83], v[82:83], v[90:91]
  v_pk_add_f32 v[64:65], v[64:65], v[80:81]
  v_pk_add_f32 v[66:67], v[66:67], v[82:83]
  v_mov_b32 v16, 0xff
  v_add_u32 v64, 0x80, v64
  v_bfi_b32 v64, v16, s30, v64
  v_add_u32 v65, 0x80, v65
  s_lshr_b32 s63, s30, 8
  v_bfi_b32 v65, v16, s63, v65
  v_add_u32 v66, 0x80, v66
  s_lshr_b32 s63, s30, 16
  v_bfi_b32 v66, v16, s63, v66
  v_add_u32 v67, 0x80, v67
  s_lshr_b32 s63, s30, 24
  v_bfi_b32 v67, v16, s63, v67
  s_mov_b32 exec_hi, 0
  buffer_store_dwordx4 v[64:67], v8, s[40:43], s48 offen sc1
  s_mov_b32 exec_hi, -1
  s_nop 1
L_x1_done:
  s_lshr_b32 s44, s26, 1
  s_sub_u32 s45, s44, s25
  s_and_b32 s45, s45, 3
  s_lshl_b32 s48, s25, 1
  s_add_u32 s48, s48, s45
  s_sub_u32 s48, s48, 2
  s_mul_i32 s56, s48, 52
  s_lshr_b32 s56, s56, 8
  s_mul_i32 s49, s56, 5
  s_sub_u32 s48, s48, s49
  s_add_u32 s48, s48, 5
  s_cmp_lt_u32 s25, 30
  s_cselect_b32 s46, s48, 15
  s_cmp_eq_u32 s45, 1
  s_cselect_b32 s46, 15, s46
  s_cselect_b32 s47, 1, 0
  s_cmp_eq_u32 s45, 0
  s_cselect_b32 s46, 4, s46
  s_bitcmp1_b32 s26, 0
  s_cselect_b32 s46, s46, s44
  s_and_b32 s47, s47, s26
  s_cmp_lt_u32 s25, 20
  s_cselect_b32 s47, s47, 0
  s_cmp_lt_u32 s46, 10
  s_cselect_b32 s6, 10, 0
  s_cmp_lt_u32 s46, 5
  s_cselect_b32 s6, 20, s6
  s_cmp_lg_u32 s24, 0
  s_cbranch_scc1 L_q_done
  s_setprio 3
  v_lshrrev_b32 v2, 4, v0
  v_and_b32 v3, 15, v0
  v_lshlrev_b32 v8, 4, v3
  v_lshl_add_u32 v8, v2, 9, v8
  v_and_b32 v9, 0x3ff, v8
  s_lshl_b32 s48, s25, 12
  s_lshl_b32 s49, s27, 8
  s_add_u32 s48, s48, s49
  s_add_u32 s48, s48, 4096
  v_and_b32 v10, 1, v3
  v_lshlrev_b32 v10, 6, v10
  v_and_b32 v11, 14, v3
  v_add_u32 v10, v11, v10
  v_lshrrev_b32 v2, 5, v0
  v_lshl_add_u32 v11, v2, 7, v10
  s_mov_b32 s62, 2976190
L_lw_111:
  ds_read_b32 v14, v13 offset:10804
  s_waitcnt lgkmcnt(0)
  v_readfirstlane_b32 s63, v14
  s_cmp_ge_u32 s63, 1
  s_cbranch_scc1 L_lok_112
  s_sleep 4
  s_sub_u32 s62, s62, 1
  s_cmp_lg_u32 s62, 0
  s_cbranch_scc1 L_lw_111
L_lok_112:
  s_mov_b32 s62, 1295336
  s_mov_b32 s66, 0x0c0c0400
  s_mov_b32 s67, 0x04000c0c
L_poll_113:
  buffer_load_dwordx4 v[16:19], v8, s[40:43], s48 offen sc1
  buffer_load_dwordx4 v[20:23], v9, s[40:43], s48 offen offset:2048 sc1
  s_waitcnt vmcnt(0)
  v_perm_b32 v32, v17, v16, s66
  v_perm_b32 v33, v19, v18, s67
  v_or_b32 v32, v32, v33
  v_cmp_ne_u32 s[64:65], s30, v32
  v_perm_b32 v32, v21, v20, s66
  v_perm_b32 v33, v23, v22, s67
  v_or_b32 v32, v32, v33
  v_cmp_ne_u32 vcc, s30, v32
  s_or_b64 s[64:65], s[64:65], vcc
  s_cmp_eq_u64 s[64:65], 0
  s_cbranch_scc1 L_ok_114
  s_sleep 8
  s_sub_u32 s62, s62, 1
  s_cmp_lg_u32 s62, 0
  s_cbranch_scc1 L_poll_113
L_ok_114:
  v_and_b32 v16, 0xffffff00, v16
  v_and_b32 v17, 0xffffff00, v17
  v_and_b32 v18, 0xffffff00, v18
  v_and_b32 v19, 0xffffff00, v19
  v_and_b32 v20, 0xffffff00, v20
  v_and_b32 v21, 0xffffff00, v21
  v_and_b32 v22, 0xffffff00, v22
  v_and_b32 v23, 0xffffff00, v23
  v_mov_b32 v24, v16
  v_mov_b32 v25, v17
  v_mov_b32 v26, v18
  v_mov_b32 v27, v19
  v_mov_b32 v28, v20
  v_mov_b32 v29, v21
  v_mov_b32 v30, v22
  v_mov_b32 v31, v23
  v_permlane16_swap_b32 v24, v16
  v_permlane16_swap_b32 v25, v17
  v_permlane16_swap_b32 v26, v18
  v_permlane16_swap_b32 v27, v19
  v_permlane16_swap_b32 v28, v20
  v_permlane16_swap_b32 v29, v21
  v_permlane16_swap_b32 v30, v22
  v_permlane16_swap_b32 v31, v23
  v_pk_add_f32 v[16:17], v[16:17], v[24:25]
  v_pk_add_f32 v[18:19], v[18:19], v[26:27]
  v_pk_add_f32 v[20:21], v[20:21], v[28:29]
  v_pk_add_f32 v[22:23], v[22:23], v[30:31]
  v_cvt_pk_bf16_f32 v16, v16, v17
  ds_write_b16 v11, v16 offset:9216
  ds_write_b16_d16_hi v11, v16 offset:9232
  v_cvt_pk_bf16_f32 v18, v18, v19
  ds_write_b16 v11, v18 offset:9248
  ds_write_b16_d16_hi v11, v18 offset:9264
  v_cvt_pk_bf16_f32 v20, v20, v21
  ds_write_b16 v10, v20 offset:9472
  ds_write_b16_d16_hi v10, v20 offset:9488
  v_cvt_pk_bf16_f32 v22, v22, v23
  ds_write_b16 v10, v22 offset:9504
  ds_write_b16_d16_hi v10, v22 offset:9520
  s_mov_b64 exec, 1
  ds_add_u32 v13, v15 offset:10764
  s_mov_b64 exec, -1
  s_setprio 0
L_q_done:
  v_lshrrev_b32 v2, 4, v0
  v_and_b32 v3, 15, v0
  v_and_b32 v11, 1, v2
  v_lshlrev_b32 v11, 2, v11
  v_xor_b32 v12, v11, v3
  v_mul_u32_u24 v8, 1280, v2
  v_lshl_add_u32 v8, v12, 4, v8
  s_lshl_b32 s57, s24, 12
  s_mul_i32 s58, s24, 20480
  s_mov_b32 s50, 0x05040100
  s_mov_b32 s51, 0x07060302
  s_lshl_b32 s49, s24, 6
  v_lshlrev_b32 v10, 8, v2
  v_lshl_add_u32 v10, v3, 2, v10
  v_add_u32 v10, s49, v10
  v_lshlrev_b32 v11, 4, v11
  v_xor_b32 v10, v11, v10
  v_add_u32 v160, 20480, v10
  v_and_b32 v2, 1, v2
  v_mul_u32_u24 v9, 2560, v2
  v_lshl_add_u32 v9, v3, 3, v9
  s_mul_i32 s55, s25, 5120
  s_lshl_b32 s53, s24, 7
  s_add_u32 s55, s55, s53
  v_and_b32 v2, 1, v0
  v_lshlrev_b32 v2, 4, v2
  v_lshrrev_b32 v100, v2, s30
  v_lshrrev_b32 v101, 8, v100
  v_mov_b32 v102, 0xff
  s_cmp_lg_u32 s24, 1
  s_cbranch_scc1 L_no_ffn
  s_sub_u32 s48, s46, 5
  s_cmp_ge_u32 s48, 5
  s_cbranch_scc1 L_no_ffn
  s_mov_b32 s62, 1016260
L_lw_115:
  ds_read_b32 v14, v13 offset:10764
  s_waitcnt lgkmcnt(0)
  v_readfirstlane_b32 s63, v14
  s_cmp_ge_u32 s63, 1
  s_cbranch_scc1 L_lok_116
  s_sleep 16
  s_sub_u32 s62, s62, 1
  s_cmp_lg_u32 s62, 0
  s_cbranch_scc1 L_lw_115
L_lok_116:
  v_lshlrev_b32 v10, 4, v0
  s_lshl_b32 s48, s56, 13
  s_add_u32 s48, s48, 7168
  s_add_u32 s49, s48, 4096
  s_mov_b32 s62, 483558
  s_mov_b32 s66, 0x0c0c0400
  s_mov_b32 s67, 0x04000c0c
L_poll_117:
  buffer_load_dwordx4 v[16:19], v10, s[40:43], s48 offen sc1
  buffer_load_dwordx4 v[20:23], v10, s[40:43], s49 offen sc1
  s_waitcnt vmcnt(0)
  v_perm_b32 v32, v17, v16, s66
  v_perm_b32 v33, v19, v18, s67
  v_or_b32 v32, v32, v33
  v_cmp_ne_u32 s[64:65], s30, v32
  v_perm_b32 v32, v21, v20, s66
  v_perm_b32 v33, v23, v22, s67
  v_or_b32 v32, v32, v33
  v_cmp_ne_u32 vcc, s30, v32
  s_or_b64 s[64:65], s[64:65], vcc
  s_cmp_eq_u64 s[64:65], 0
  s_cbranch_scc1 L_ok_118
  s_sleep 32
  s_sub_u32 s62, s62, 1
  s_cmp_lg_u32 s62, 0
  s_cbranch_scc1 L_poll_117
L_ok_118:
  v_and_b32 v16, 0xffffff00, v16
  v_and_b32 v17, 0xffffff00, v17
  v_and_b32 v18, 0xffffff00, v18
  v_and_b32 v19, 0xffffff00, v19
  v_and_b32 v20, 0xffffff00, v20
  v_and_b32 v21, 0xffffff00, v21
  v_and_b32 v22, 0xffffff00, v22
  v_and_b32 v23, 0xffffff00, v23
  v_and_b32 v10, 31, v0
  v_lshlrev_b32 v10, 3, v10
  v_mov_b32 v24, v16
  v_mov_b32 v25, v17
  v_mov_b32 v26, v18
  v_mov_b32 v27, v19
  v_mov_b32 v28, v20
  v_mov_b32 v29, v21
  v_mov_b32 v30, v22
  v_mov_b32 v31, v23
  v_permlane32_swap_b32 v24, v16
  v_permlane32_swap_b32 v25, v17
  v_permlane32_swap_b32 v26, v18
  v_permlane32_swap_b32 v27, v19
  v_permlane32_swap_b32 v28, v20
  v_permlane32_swap_b32 v29, v21
  v_permlane32_swap_b32 v30, v22
  v_permlane32_swap_b32 v31, v23
  v_pk_add_f32 v[16:17], v[16:17], v[24:25]
  v_pk_add_f32 v[18:19], v[18:19], v[26:27]
  v_pk_add_f32 v[20:21], v[20:21], v[28:29]
  v_pk_add_f32 v[22:23], v[22:23], v[30:31]
  v_max_f32 v16, 0, v16
  v_max_f32 v17, 0, v17
  v_max_f32 v18, 0, v18
  v_max_f32 v19, 0, v19
  v_max_f32 v20, 0, v20
  v_max_f32 v21, 0, v21
  v_max_f32 v22, 0, v22
  v_max_f32 v23, 0, v23
  v_cvt_pk_bf16_f32 v24, v16, v17
  v_cvt_pk_bf16_f32 v25, v18, v19
  ds_write_b64 v10, v[24:25] offset:9728
  v_cvt_pk_bf16_f32 v26, v20, v21
  v_cvt_pk_bf16_f32 v27, v22, v23
  ds_write_b64 v10, v[26:27] offset:9984
  s_mov_b64 exec, 1
  ds_add_u32 v13, v15 offset:10756
  s_mov_b64 exec, -1
L_no_ffn:
  s_cmp_lg_u32 s24, 2
  s_cbranch_scc1 L_sc_119
  s_lshr_b32 s44, s25, 2
  s_add_u32 s45, s44, s26
  s_and_b32 s45, s45, 7
  s_lshl_b32 s45, s45, 2
  s_and_b32 s48, s25, 3
  s_add_u32 s45, s45, s48
  s_lshl_b32 s45, s45, 7
  s_add_u32 s45, s45, 544768
  s_lshl_b32 s44, s44, 4
  s_add_u32 s44, s44, s45
  s_and_b32 s45, s45, 0xfffffe7f
  v_and_b32 v2, 31, v0
  v_lshlrev_b32 v10, 4, v2
  v_mov_b32 v18, s30
  v_mov_b32 v19, s31
  s_mov_b32 s62, 4385964
L_lw_120:
  ds_read_b32 v14, v13 offset:10788
  s_waitcnt lgkmcnt(0)
  v_readfirstlane_b32 s63, v14
  s_cmp_ge_u32 s63, 4
  s_cbranch_scc1 L_lok_121
  s_sleep 2
  s_sub_u32 s62, s62, 1
  s_cmp_lg_u32 s62, 0
  s_cbranch_scc1 L_lw_120
L_lok_121:
  s_memrealtime s[48:49]
  s_waitcnt lgkmcnt(0)
  s_mov_b32 s7, s48
  s_mov_b32 s62, 4385964
L_lw_122:
  ds_read_b32 v14, v13 offset:10788
  s_waitcnt lgkmcnt(0)
  v_readfirstlane_b32 s63, v14
  s_cmp_ge_u32 s63, 8
  s_cbranch_scc1 L_lok_123
  s_sleep 2
  s_sub_u32 s62, s62, 1
  s_cmp_lg_u32 s62, 0
  s_cbranch_scc1 L_lw_122
L_lok_123:
  s_memrealtime s[48:49]
  s_waitcnt lgkmcnt(0)
  s_sub_u32 s7, s48, s7
  s_add_u32 s59, s48, s6
  v_mov_b32 v16, s59
  v_mov_b32 v17, s7
  s_mov_b64 exec, 1
  buffer_store_dwordx4 v[16:19], off, s[40:43], s44 sc1
  s_mov_b64 exec, -1
  s_mov_b32 s62, 4385964
L_lw_124:
  ds_read_b32 v14, v13 offset:10788
  s_waitcnt lgkmcnt(0)
  v_readfirstlane_b32 s63, v14
  s_cmp_ge_u32 s63, 12
  s_cbranch_scc1 L_lok_125
  s_sleep 2
  s_sub_u32 s62, s62, 1
  s_cmp_lg_u32 s62, 0
  s_cbranch_scc1 L_lw_124
L_lok_125:
  buffer_load_dwordx4 v[20:23], v10, s[40:43], s45 offen sc1
  s_waitcnt vmcnt(0)
  v_cmp_eq_u64 vcc, s[30:31], v[22:23]
  v_subrev_u32 v20, s59, v20
  v_cvt_f32_i32 v20, v20
  v_cvt_f32_i32 v21, v21
  v_cndmask_b32 v20, 0, v20, vcc
  v_cndmask_b32 v21, 0, v21, vcc
  v_cndmask_b32 v22, 0, 1.0, vcc
  v_add_f32_dpp v20, v20, v20 quad_perm:[1,0,3,2] row_mask:0xf bank_mask:0xf
  v_add_f32_dpp v21, v21, v21 quad_perm:[1,0,3,2] row_mask:0xf bank_mask:0xf
  v_add_f32_dpp v22, v22, v22 quad_perm:[1,0,3,2] row_mask:0xf bank_mask:0xf
  v_add_f32_dpp v20, v20, v20 quad_perm:[2,3,0,1] row_mask:0xf bank_mask:0xf
  v_add_f32_dpp v21, v21, v21 quad_perm:[2,3,0,1] row_mask:0xf bank_mask:0xf
  v_add_f32_dpp v22, v22, v22 quad_perm:[2,3,0,1] row_mask:0xf bank_mask:0xf
  v_add_f32_dpp v20, v20, v20 row_half_mirror row_mask:0xf bank_mask:0xf
  v_add_f32_dpp v21, v21, v21 row_half_mirror row_mask:0xf bank_mask:0xf
  v_add_f32_dpp v22, v22, v22 row_half_mirror row_mask:0xf bank_mask:0xf
  v_add_f32_dpp v20, v20, v20 row_mirror row_mask:0xf bank_mask:0xf
  v_add_f32_dpp v21, v21, v21 row_mirror row_mask:0xf bank_mask:0xf
  v_add_f32_dpp v22, v22, v22 row_mirror row_mask:0xf bank_mask:0xf
  v_mov_b32 v24, v20
  s_nop 1
  v_permlane16_swap_b32 v24, v20
  v_add_f32 v20, v24, v20
  v_mov_b32 v24, v21
  s_nop 1
  v_permlane16_swap_b32 v24, v21
  v_add_f32 v21, v24, v21
  v_mov_b32 v24, v22
  s_nop 1
  v_permlane16_swap_b32 v24, v22
  v_add_f32 v22, v24, v22
  v_max_f32 v22, 1.0, v22
  v_rcp_f32 v22, v22
  s_nop 0
  v_mul_f32 v20, v20, v22
  v_mul_f32 v21, v21, v22
  v_mul_f32 v20, 0x42800000, v20
  v_mul_f32 v21, 0x4009374c, v21
  v_cvt_i32_f32 v20, v20
  v_cvt_i32_f32 v21, v21
  s_sub_u32 s48, s48, 7
  s_lshl_b32 s48, s48, 6
  v_add_u32 v20, s48, v20
  v_mul_u32_u24 v22, 126, v21
  v_sub_u32 v20, v20, v22
  s_mov_b64 exec, 1
  ds_write_b64 v13, v[20:21] offset:10944
  s_mov_b64 exec, -1
L_sc_119:
  s_cmp_lg_u32 s24, 3
  s_cbranch_scc1 L_no_ml
  v_and_b32 v2, 3, v0
  v_lshlrev_b32 v3, 3, v2
  v_lshlrev_b32 v11, 4, v2
  v_mov_b32 v18, s30
  v_mov_b32 v19, s31
  s_lshl_b32 s48, s2, 6
  s_add_u32 s48, s48, 528384
  s_mov_b32 s62, 1811594
L_lw_126:
  ds_read_b32 v14, v13 offset:10768
  s_waitcnt lgkmcnt(0)
  v_readfirstlane_b32 s63, v14
  s_cmp_ge_u32 s63, 4
  s_cbranch_scc1 L_lok_127
  s_sleep 8
  s_sub_u32 s62, s62, 1
  s_cmp_lg_u32 s62, 0
  s_cbranch_scc1 L_lw_126
L_lok_127:
  ds_read_b64 v[16:17], v3 offset:10880
  s_mov_b64 exec, 15
  s_waitcnt lgkmcnt(0)
  buffer_store_dwordx4 v[16:19], v11, s[40:43], s48 offen sc1
  s_mov_b64 exec, -1
  s_waitcnt vmcnt(0)
  v_and_b32 v2, 31, v0
  v_lshlrev_b32 v10, 4, v2
  s_lshl_b32 s48, s25, 9
  s_add_u32 s48, s48, 528384
  s_lshl_b32 s49, s27, 4
  s_mov_b32 s62, 704225
L_poll_128:
  buffer_load_dwordx4 v[16:19], v10, s[40:43], s48 offen sc1
  s_waitcnt vmcnt(0)
  v_cmp_ne_u64 s[64:65], s[30:31], v[18:19]
  s_cmp_eq_u64 s[64:65], 0
  s_cbranch_scc1 L_ok_129
  s_sleep 20
  s_sub_u32 s62, s62, 1
  s_cmp_lg_u32 s62, 0
  s_cbranch_scc1 L_poll_128
L_ok_129:
  ds_read_b32 v24, v3 offset:10912
  v_readlane_b32 s59, v16, s49
  s_nop 1
  v_subrev_u32 v21, s59, v16
  v_bfe_i32 v21, v21, 0, 16
  v_cvt_f32_i32 v21, v21
  v_mov_b32 v22, v21
  s_nop 1
  v_add_f32_dpp v22, v22, v22 quad_perm:[1,0,3,2] row_mask:0xf bank_mask:0xf
  s_nop 1
  v_add_f32_dpp v22, v22, v22 quad_perm:[2,3,0,1] row_mask:0xf bank_mask:0xf
  s_nop 1
  v_add_f32_dpp v22, v22, v22 row_half_mirror row_mask:0xf bank_mask:0xf
  s_nop 1
  v_add_f32_dpp v22, v22, v22 row_mirror row_mask:0xf bank_mask:0xf
  v_mov_b32 v23, v22
  s_nop 1
  v_permlane16_swap_b32 v23, v22
  v_add_f32 v22, v23, v22
  v_mul_f32 v22, 0x3d000000, v22
  v_sub_f32 v21, v21, v22
  v_cvt_f32_u32 v22, s6
  v_subrev_f32 v22, 0x41700000, v22
  v_add_f32 v21, v22, v21
  v_mul_f32 v23, 0xbf0ccccd, v21
  v_mul_f32 v22, 0x3ecccccd, v21
  v_cvt_i32_f32 v22, v22
  v_cvt_i32_f32 v23, v23
  s_waitcnt lgkmcnt(0)
  v_max_i32 v24, 105, v24
  v_add_u32 v24, 4, v24
  v_add_u32 v22, v24, v22
  v_add_u32 v23, v24, v23
  v_and_b32 v16, 0xffff0000, v16
  v_mov_b32 v20, v16
  s_nop 1
  v_max_f32_dpp v20, v20, v20 quad_perm:[1,0,3,2] row_mask:0xf bank_mask:0xf
  s_nop 1
  v_max_f32_dpp v20, v20, v20 quad_perm:[2,3,0,1] row_mask:0xf bank_mask:0xf
  s_nop 1
  v_max_f32_dpp v20, v20, v20 row_half_mirror row_mask:0xf bank_mask:0xf
  s_nop 1
  v_max_f32_dpp v20, v20, v20 row_mirror row_mask:0xf bank_mask:0xf
  v_sub_f32 v16, v16, v20
  v_mul_f32 v16, 0x3fb8aa3b, v16
  v_exp_f32 v16, v16
  s_nop 0
  v_mul_f32 v17, v16, v17
  s_nop 1
  v_add_f32_dpp v17, v17, v17 quad_perm:[1,0,3,2] row_mask:0xf bank_mask:0xf
  s_nop 1
  v_add_f32_dpp v17, v17, v17 quad_perm:[2,3,0,1] row_mask:0xf bank_mask:0xf
  s_nop 1
  v_add_f32_dpp v17, v17, v17 row_half_mirror row_mask:0xf bank_mask:0xf
  s_nop 1
  v_add_f32_dpp v17, v17, v17 row_mirror row_mask:0xf bank_mask:0xf
  v_rcp_f32 v17, v17
  s_nop 0
  v_mul_f32 v16, v16, v17
  v_and_b32 v2, 3, v0
  v_lshlrev_b32 v2, 2, v2
  s_lshl_b32 s48, s26, 2
  s_lshl_b64 exec, 15, s48
  ds_write_b32 v2, v16 offset:10816
  ds_write_b64 v3, v[22:23] offset:10832
  s_mov_b64 exec, -1
  s_mov_b64 exec, 1
  ds_add_u32 v13, v15 offset:10760
  s_mov_b64 exec, -1
L_no_ml:
  s_mov_b32 s8, s20
  s_mov_b32 s9, s21
  s_mov_b32 s10, 2560
  s_mov_b32 s11, 0x20000
  v_lshrrev_b32 v2, 3, v0
  v_and_b32 v3, 7, v0
  v_mul_u32_u24 v200, 10240, v2
  v_lshl_add_u32 v200, v3, 4, v200
  v_lshlrev_b32 v201, 2, v3
L_no_gate:
  v_and_b32 v2, 7, v0
  v_mul_u32_u24 v12, 400, v2
  v_lshrrev_b32 v2, 4, v0
  v_lshl_add_u32 v12, v2, 4, v12
  v_mov_b32 v98, s30
  v_mov_b32 v99, s31
  s_cmp_ge_u32 s46, 10
  s_cbranch_scc1 L_reduce
  s_cmp_ge_u32 s46, 5
  s_cbranch_scc1 L_ffn2
  s_lshl_b32 s48, s46, 8
  s_mul_i32 s49, s25, 245760
  s_add_u32 s49, s49, s48
  s_add_u32 s32, s12, s49
  s_addc_u32 s33, s13, 0
  s_sub_u32 s34, 245760, s48
  s_mov_b32 s35, 0x20000
  s_lshl_b32 s52, s46, 9
  s_add_u32 s52, s52, s55
  s_add_u32 s52, s52, 1085440
  s_mov_b32 s62, 5747126
L_lw_130:
  ds_read_b32 v14, v13 offset:10772
  s_waitcnt lgkmcnt(0)
  v_readfirstlane_b32 s63, v14
  s_cmp_ge_u32 s63, 4
  s_cbranch_scc1 L_lok_131
  s_sleep 1
  s_sub_u32 s62, s62, 1
  s_cmp_lg_u32 s62, 0
  s_cbranch_scc1 L_lw_130
L_lok_131:
  s_add_u32 m0, s57, 20480
  s_add_u32 s59, s58, 0
  buffer_load_dwordx4 v8, s[32:35], s59 offen nt lds
  s_add_u32 m0, s57, 21504
  s_add_u32 s59, s58, 5120
  buffer_load_dwordx4 v8, s[32:35], s59 offen nt lds
  s_add_u32 m0, s57, 22528
  s_add_u32 s59, s58, 10240
  buffer_load_dwordx4 v8, s[32:35], s59 offen nt lds
  s_add_u32 m0, s57, 23552
  s_add_u32 s59, s58, 15360
  buffer_load_dwordx4 v8, s[32:35], s59 offen nt lds
  s_add_u32 m0, s57, 36864
  s_add_u32 s59, s58, 81920
  buffer_load_dwordx4 v8, s[32:35], s59 offen nt lds
  s_add_u32 m0, s57, 37888
  s_add_u32 s59, s58, 87040
  buffer_load_dwordx4 v8, s[32:35], s59 offen nt lds
  s_add_u32 m0, s57, 38912
  s_add_u32 s59, s58, 92160
  buffer_load_dwordx4 v8, s[32:35], s59 offen nt lds
  s_add_u32 m0, s57, 39936
  s_add_u32 s59, s58, 97280
  buffer_load_dwordx4 v8, s[32:35], s59 offen nt lds
  s_add_u32 m0, s57, 53248
  s_add_u32 s59, s58, 163840
  buffer_load_dwordx4 v8, s[32:35], s59 offen nt lds
  s_add_u32 m0, s57, 54272
  s_add_u32 s59, s58, 168960
  buffer_load_dwordx4 v8, s[32:35], s59 offen nt lds
  s_add_u32 m0, s57, 55296
  s_add_u32 s59, s58, 174080
  buffer_load_dwordx4 v8, s[32:35], s59 offen nt lds
  s_add_u32 m0, s57, 56320
  s_add_u32 s59, s58, 179200
  buffer_load_dwordx4 v8, s[32:35], s59 offen nt lds
  s_waitcnt vmcnt(8)
  s_mov_b64 exec, 1
  ds_add_u32 v13, v15 offset:10792
  s_mov_b64 exec, -1
  s_mov_b32 s62, 8333333
L_lw_132:
  ds_read_b32 v14, v13 offset:10792
  s_waitcnt lgkmcnt(0)
  v_readfirstlane_b32 s63, v14
  s_cmp_ge_u32 s63, 4
  s_cbranch_scc1 L_lok_133
  s_sub_u32 s62, s62, 1
  s_cmp_lg_u32 s62, 0
  s_cbranch_scc1 L_lw_132
L_lok_133:
  ds_read2st64_b32 v[64:65], v160 offset0:0 offset1:8
  ds_read2st64_b32 v[66:67], v160 offset0:16 offset1:24
  ds_read2st64_b32 v[68:69], v160 offset0:32 offset1:40
  ds_read2st64_b32 v[70:71], v160 offset0:48 offset1:56
  ds_read2st64_b32 v[72:73], v160 offset0:4 offset1:12
  ds_read2st64_b32 v[74:75], v160 offset0:20 offset1:28
  ds_read2st64_b32 v[76:77], v160 offset0:36 offset1:44
  ds_read2st64_b32 v[78:79], v160 offset0:52 offset1:60
  s_waitcnt lgkmcnt(7)
  v_perm_b32 v112, v65, v64, s50
  v_perm_b32 v116, v65, v64, s51
  s_waitcnt lgkmcnt(6)
  v_perm_b32 v113, v67, v66, s50
  v_perm_b32 v117, v67, v66, s51
  s_waitcnt lgkmcnt(5)
  v_perm_b32 v114, v69, v68, s50
  v_perm_b32 v118, v69, v68, s51
  s_waitcnt lgkmcnt(4)
  v_perm_b32 v115, v71, v70, s50
  v_perm_b32 v119, v71, v70, s51
  s_waitcnt lgkmcnt(3)
  v_perm_b32 v120, v73, v72, s50
  v_perm_b32 v124, v73, v72, s51
  s_waitcnt lgkmcnt(2)
  v_perm_b32 v121, v75, v74, s50
  v_perm_b32 v125, v75, v74, s51
  s_waitcnt lgkmcnt(1)
  v_perm_b32 v122, v77, v76, s50
  v_perm_b32 v126, v77, v76, s51
  s_waitcnt lgkmcnt(0)
  v_perm_b32 v123, v79, v78, s50
  v_perm_b32 v127, v79, v78, s51
  s_waitcnt vmcnt(4)
  s_mov_b64 exec, 1
  ds_add_u32 v13, v15 offset:10796
  s_mov_b64 exec, -1
  s_mov_b32 s62, 8333333
L_lw_134:
  ds_read_b32 v14, v13 offset:10796
  s_waitcnt lgkmcnt(0)
  v_readfirstlane_b32 s63, v14
  s_cmp_ge_u32 s63, 4
  s_cbranch_scc1 L_lok_135
  s_sub_u32 s62, s62, 1
  s_cmp_lg_u32 s62, 0
  s_cbranch_scc1 L_lw_134
L_lok_135:
  ds_read2st64_b32 v[64:65], v160 offset0:64 offset1:72
  ds_read2st64_b32 v[66:67], v160 offset0:80 offset1:88
  ds_read2st64_b32 v[68:69], v160 offset0:96 offset1:104
  ds_read2st64_b32 v[70:71], v160 offset0:112 offset1:120
  ds_read2st64_b32 v[72:73], v160 offset0:68 offset1:76
  ds_read2st64_b32 v[74:75], v160 offset0:84 offset1:92
  ds_read2st64_b32 v[76:77], v160 offset0:100 offset1:108
  ds_read2st64_b32 v[78:79], v160 offset0:116 offset1:124
  s_waitcnt lgkmcnt(7)
  v_perm_b32 v128, v65, v64, s50
  v_perm_b32 v132, v65, v64, s51
  s_waitcnt lgkmcnt(6)
  v_perm_b32 v129, v67, v66, s50
  v_perm_b32 v133, v67, v66, s51
  s_waitcnt lgkmcnt(5)
  v_perm_b32 v130, v69, v68, s50
  v_perm_b32 v134, v69, v68, s51
  s_waitcnt lgkmcnt(4)
  v_perm_b32 v131, v71, v70, s50
  v_perm_b32 v135, v71, v70, s51
  s_waitcnt lgkmcnt(3)
  v_perm_b32 v136, v73, v72, s50
  v_perm_b32 v140, v73, v72, s51
  s_waitcnt lgkmcnt(2)
  v_perm_b32 v137, v75, v74, s50
  v_perm_b32 v141, v75, v74, s51
  s_waitcnt lgkmcnt(1)
  v_perm_b32 v138, v77, v76, s50
  v_perm_b32 v142, v77, v76, s51
  s_waitcnt lgkmcnt(0)
  v_perm_b32 v139, v79, v78, s50
  v_perm_b32 v143, v79, v78, s51
  s_waitcnt vmcnt(0)
  s_mov_b64 exec, 1
  ds_add_u32 v13, v15 offset:10800
  s_mov_b64 exec, -1
  s_mov_b32 s62, 8333333
L_lw_136:
  ds_read_b32 v14, v13 offset:10800
  s_waitcnt lgkmcnt(0)
  v_readfirstlane_b32 s63, v14
  s_cmp_ge_u32 s63, 4
  s_cbranch_scc1 L_lok_137
  s_sub_u32 s62, s62, 1
  s_cmp_lg_u32 s62, 0
  s_cbranch_scc1 L_lw_136
L_lok_137:
  ds_read2st64_b32 v[64:65], v160 offset0:128 offset1:136
  ds_read2st64_b32 v[66:67], v160 offset0:144 offset1:152
  ds_read2st64_b32 v[68:69], v160 offset0:160 offset1:168
  ds_read2st64_b32 v[70:71], v160 offset0:176 offset1:184
  ds_read2st64_b32 v[72:73], v160 offset0:132 offset1:140
  ds_read2st64_b32 v[74:75], v160 offset0:148 offset1:156
  ds_read2st64_b32 v[76:77], v160 offset0:164 offset1:172
  ds_read2st64_b32 v[78:79], v160 offset0:180 offset1:188
  s_waitcnt lgkmcnt(7)
  v_perm_b32 v144, v65, v64, s50
  v_perm_b32 v148, v65, v64, s51
  s_waitcnt lgkmcnt(6)
  v_perm_b32 v145, v67, v66, s50
  v_perm_b32 v149, v67, v66, s51
  s_waitcnt lgkmcnt(5)
  v_perm_b32 v146, v69, v68, s50
  v_perm_b32 v150, v69, v68, s51
  s_waitcnt lgkmcnt(4)
  v_perm_b32 v147, v71, v70, s50
  v_perm_b32 v151, v71, v70, s51
  s_waitcnt lgkmcnt(3)
  v_perm_b32 v152, v73, v72, s50
  v_perm_b32 v156, v73, v72, s51
  s_waitcnt lgkmcnt(2)
  v_perm_b32 v153, v75, v74, s50
  v_perm_b32 v157, v75, v74, s51
  s_waitcnt lgkmcnt(1)
  v_perm_b32 v154, v77, v76, s50
  v_perm_b32 v158, v77, v76, s51
  s_waitcnt lgkmcnt(0)
  v_perm_b32 v155, v79, v78, s50
  v_perm_b32 v159, v79, v78, s51
  s_barrier
  ds_read_b128 v[16:19], v12 offset:17152
  ds_read_b128 v[20:23], v12 offset:17216
  ds_read_b128 v[24:27], v12 offset:17280
  ds_read_b128 v[28:31], v12 offset:17344
  ds_read_b128 v[32:35], v12 offset:17408
  ds_read_b128 v[36:39], v12 offset:17472
  s_waitcnt lgkmcnt(5)
  v_mfma_f32_16x16x32_bf16 v[80:83], v[16:19], v[112:115], 0
  v_mfma_f32_16x16x32_bf16 v[84:87], v[16:19], v[116:119], 0
  s_waitcnt lgkmcnt(4)
  v_mfma_f32_16x16x32_bf16 v[88:91], v[20:23], v[120:123], 0
  v_mfma_f32_16x16x32_bf16 v[92:95], v[20:23], v[124:127], 0
  s_waitcnt lgkmcnt(3)
  v_mfma_f32_16x16x32_bf16 v[80:83], v[24:27], v[128:131], v[80:83]
  v_mfma_f32_16x16x32_bf16 v[84:87], v[24:27], v[132:135], v[84:87]
  s_waitcnt lgkmcnt(2)
  v_mfma_f32_16x16x32_bf16 v[88:91], v[28:31], v[136:139], v[88:91]
  v_mfma_f32_16x16x32_bf16 v[92:95], v[28:31], v[140:143], v[92:95]
  s_waitcnt lgkmcnt(1)
  v_mfma_f32_16x16x32_bf16 v[80:83], v[32:35], v[144:147], v[80:83]
  v_mfma_f32_16x16x32_bf16 v[84:87], v[32:35], v[148:151], v[84:87]
  s_waitcnt lgkmcnt(0)
  v_mfma_f32_16x16x32_bf16 v[88:91], v[36:39], v[152:155], v[88:91]
  v_mfma_f32_16x16x32_bf16 v[92:95], v[36:39], v[156:159], v[92:95]
  s_mov_b32 exec_hi, 0
  s_nop 2
  v_pk_add_f32 v[80:81], v[80:81], v[82:83]
  v_pk_add_f32 v[84:85], v[84:85], v[86:87]
  s_nop 0
  v_pk_add_f32 v[88:89], v[88:89], v[90:91]
  v_pk_add_f32 v[92:93], v[92:93], v[94:95]
  v_pk_add_f32 v[80:81], v[80:81], v[88:89]
  v_pk_add_f32 v[84:85], v[84:85], v[92:93]
  v_add_f32 v96, v80, v81
  v_add_f32 v97, v84, v85
  v_add_u32 v96, 0x80, v96
  v_add_u32 v97, 0x80, v97
  v_bfi_b32 v96, v102, v100, v96
  v_bfi_b32 v97, v102, v101, v97
  s_nop 0
  v_mov_b32_dpp v98, v96 quad_perm:[1,0,3,2] row_mask:0xf bank_mask:0xf
  v_mov_b32_dpp v99, v97 quad_perm:[1,0,3,2] row_mask:0xf bank_mask:0xf
  s_mov_b32 exec_lo, 0x55555555
  buffer_store_dwordx4 v[96:99], v9, s[40:43], s52 offen sc1
  s_mov_b32 exec_lo, -1
  s_mov_b32 exec_hi, -1
  s_endpgm
L_ffn2:
  s_sub_u32 s46, s46, 5
  s_lshl_b32 s48, s46, 8
  s_mul_i32 s49, s56, 163840
  s_add_u32 s49, s49, s48
  s_add_u32 s32, s18, s49
  s_addc_u32 s33, s19, 0
  s_sub_u32 s34, 163840, s48
  s_mov_b32 s35, 0x20000
  s_mul_i32 s52, s56, 5120
  s_lshl_b32 s53, s24, 7
  s_add_u32 s52, s52, s53
  s_lshl_b32 s53, s46, 9
  s_add_u32 s52, s52, s53
  s_add_u32 s52, s52, 823296
  v_bfe_u32 v11, v0, 2, 1
  v_lshlrev_b32 v11, 7, v11
  v_lshrrev_b32 v2, 4, v0
  v_lshl_add_u32 v11, v2, 4, v11
  s_mov_b32 s62, 1016260
L_lw_138:
  ds_read_b32 v14, v13 offset:10756
  s_waitcnt lgkmcnt(0)
  v_readfirstlane_b32 s63, v14
  s_cmp_ge_u32 s63, 1
  s_cbranch_scc1 L_lok_139
  s_sleep 16
  s_sub_u32 s62, s62, 1
  s_cmp_lg_u32 s62, 0
  s_cbranch_scc1 L_lw_138
L_lok_139:
  ds_read_b128 v[16:19], v11 offset:9728
  ds_read_b128 v[20:23], v11 offset:9792
  ds_read_b128 v[24:27], v11 offset:9984
  ds_read_b128 v[28:31], v11 offset:10048
  s_mov_b32 s62, 5747126
L_lw_140:
  ds_read_b32 v14, v13 offset:10772
  s_waitcnt lgkmcnt(0)
  v_readfirstlane_b32 s63, v14
  s_cmp_ge_u32 s63, 4
  s_cbranch_scc1 L_lok_141
  s_sleep 1
  s_sub_u32 s62, s62, 1
  s_cmp_lg_u32 s62, 0
  s_cbranch_scc1 L_lw_140
L_lok_141:
  s_add_u32 m0, s57, 20480
  s_add_u32 s59, s58, 0
  buffer_load_dwordx4 v8, s[32:35], s59 offen nt lds
  s_add_u32 m0, s57, 21504
  s_add_u32 s59, s58, 5120
  buffer_load_dwordx4 v8, s[32:35], s59 offen nt lds
  s_add_u32 m0, s57, 22528
  s_add_u32 s59, s58, 10240
  buffer_load_dwordx4 v8, s[32:35], s59 offen nt lds
  s_add_u32 m0, s57, 23552
  s_add_u32 s59, s58, 15360
  buffer_load_dwordx4 v8, s[32:35], s59 offen nt lds
  s_waitcnt vmcnt(3)
  s_add_u32 m0, s57, 36864
  s_add_u32 s59, s58, 81920
  buffer_load_dwordx4 v8, s[32:35], s59 offen nt lds
  s_waitcnt vmcnt(3)
  s_add_u32 m0, s57, 37888
  s_add_u32 s59, s58, 87040
  buffer_load_dwordx4 v8, s[32:35], s59 offen nt lds
  s_waitcnt vmcnt(3)
  s_add_u32 m0, s57, 38912
  s_add_u32 s59, s58, 92160
  buffer_load_dwordx4 v8, s[32:35], s59 offen nt lds
  s_waitcnt vmcnt(3)
  s_add_u32 m0, s57, 39936
  s_add_u32 s59, s58, 97280
  buffer_load_dwordx4 v8, s[32:35], s59 offen nt lds
  s_waitcnt vmcnt(4)
  s_mov_b64 exec, 1
  ds_add_u32 v13, v15 offset:10792
  s_mov_b64 exec, -1
  s_mov_b32 s62, 8333333
L_lw_142:
  ds_read_b32 v14, v13 offset:10792
  s_waitcnt lgkmcnt(0)
  v_readfirstlane_b32 s63, v14
  s_cmp_ge_u32 s63, 4
  s_cbranch_scc1 L_lok_143
  s_sub_u32 s62, s62, 1
  s_cmp_lg_u32 s62, 0
  s_cbranch_scc1 L_lw_142
L_lok_143:
  ds_read2st64_b32 v[64:65], v160 offset0:0 offset1:8
  ds_read2st64_b32 v[66:67], v160 offset0:16 offset1:24
  ds_read2st64_b32 v[68:69], v160 offset0:32 offset1:40
  ds_read2st64_b32 v[70:71], v160 offset0:48 offset1:56
  ds_read2st64_b32 v[72:73], v160 offset0:4 offset1:12
  ds_read2st64_b32 v[74:75], v160 offset0:20 offset1:28
  ds_read2st64_b32 v[76:77], v160 offset0:36 offset1:44
  ds_read2st64_b32 v[78:79], v160 offset0:52 offset1:60
  s_waitcnt lgkmcnt(7)
  v_perm_b32 v112, v65, v64, s50
  v_perm_b32 v116, v65, v64, s51
  s_waitcnt lgkmcnt(6)
  v_perm_b32 v113, v67, v66, s50
  v_perm_b32 v117, v67, v66, s51
  s_waitcnt lgkmcnt(5)
  v_perm_b32 v114, v69, v68, s50
  v_perm_b32 v118, v69, v68, s51
  s_waitcnt lgkmcnt(4)
  v_perm_b32 v115, v71, v70, s50
  v_perm_b32 v119, v71, v70, s51
  s_waitcnt lgkmcnt(3)
  v_perm_b32 v120, v73, v72, s50
  v_perm_b32 v124, v73, v72, s51
  s_waitcnt lgkmcnt(2)
  v_perm_b32 v121, v75, v74, s50
  v_perm_b32 v125, v75, v74, s51
  s_waitcnt lgkmcnt(1)
  v_perm_b32 v122, v77, v76, s50
  v_perm_b32 v126, v77, v76, s51
  s_waitcnt lgkmcnt(0)
  v_perm_b32 v123, v79, v78, s50
  v_perm_b32 v127, v79, v78, s51
  v_mfma_f32_16x16x32_bf16 v[80:83], v[16:19], v[112:115], 0
  v_mfma_f32_16x16x32_bf16 v[84:87], v[16:19], v[116:119], 0
  v_mfma_f32_16x16x32_bf16 v[88:91], v[20:23], v[120:123], 0
  v_mfma_f32_16x16x32_bf16 v[92:95], v[20:23], v[124:127], 0
  s_waitcnt vmcnt(0)
  s_mov_b64 exec, 1
  ds_add_u32 v13, v15 offset:10796
  s_mov_b64 exec, -1
  s_mov_b32 s62, 8333333
L_lw_144:
  ds_read_b32 v14, v13 offset:10796
  s_waitcnt lgkmcnt(0)
  v_readfirstlane_b32 s63, v14
  s_cmp_ge_u32 s63, 4
  s_cbranch_scc1 L_lok_145
  s_sub_u32 s62, s62, 1
  s_cmp_lg_u32 s62, 0
  s_cbranch_scc1 L_lw_144
L_lok_145:
  ds_read2st64_b32 v[64:65], v160 offset0:64 offset1:72
  ds_read2st64_b32 v[66:67], v160 offset0:80 offset1:88
  ds_read2st64_b32 v[68:69], v160 offset0:96 offset1:104
  ds_read2st64_b32 v[70:71], v160 offset0:112 offset1:120
  ds_read2st64_b32 v[72:73], v160 offset0:68 offset1:76
  ds_read2st64_b32 v[74:75], v160 offset0:84 offset1:92
  ds_read2st64_b32 v[76:77], v160 offset0:100 offset1:108
  ds_read2st64_b32 v[78:79], v160 offset0:116 offset1:124
  s_waitcnt lgkmcnt(7)
  v_perm_b32 v128, v65, v64, s50
  v_perm_b32 v132, v65, v64, s51
  s_waitcnt lgkmcnt(6)
  v_perm_b32 v129, v67, v66, s50
  v_perm_b32 v133, v67, v66, s51
  s_waitcnt lgkmcnt(5)
  v_perm_b32 v130, v69, v68, s50
  v_perm_b32 v134, v69, v68, s51
  s_waitcnt lgkmcnt(4)
  v_perm_b32 v131, v71, v70, s50
  v_perm_b32 v135, v71, v70, s51
  s_waitcnt lgkmcnt(3)
  v_perm_b32 v136, v73, v72, s50
  v_perm_b32 v140, v73, v72, s51
  s_waitcnt lgkmcnt(2)
  v_perm_b32 v137, v75, v74, s50
  v_perm_b32 v141, v75, v74, s51
  s_waitcnt lgkmcnt(1)
  v_perm_b32 v138, v77, v76, s50
  v_perm_b32 v142, v77, v76, s51
  s_waitcnt lgkmcnt(0)
  v_perm_b32 v139, v79, v78, s50
  v_perm_b32 v143, v79, v78, s51
  v_mfma_f32_16x16x32_bf16 v[80:83], v[24:27], v[128:131], v[80:83]
  v_mfma_f32_16x16x32_bf16 v[84:87], v[24:27], v[132:135], v[84:87]
  v_mfma_f32_16x16x32_bf16 v[88:91], v[28:31], v[136:139], v[88:91]
  v_mfma_f32_16x16x32_bf16 v[92:95], v[28:31], v[140:143], v[92:95]
  s_mov_b32 exec_hi, 0
  s_nop 5
  v_add_f32 v96, v80, v88
  v_add_f32 v97, v84, v92
  v_add_u32 v96, 0x80, v96
  v_add_u32 v97, 0x80, v97
  v_bfi_b32 v96, v102, v100, v96
  v_bfi_b32 v97, v102, v101, v97
  s_nop 0
  v_mov_b32_dpp v98, v96 quad_perm:[1,0,3,2] row_mask:0xf bank_mask:0xf
  v_mov_b32_dpp v99, v97 quad_perm:[1,0,3,2] row_mask:0xf bank_mask:0xf
  s_mov_b32 exec_lo, 0x55555555
  buffer_store_dwordx4 v[96:99], v9, s[40:43], s52 offen sc1
  s_mov_b32 exec_lo, -1
  s_endpgm
L_reduce:
  s_cmp_eq_u32 s47, 0
  s_cbranch_scc1 L_end
  s_lshl_b32 s52, s25, 2
  s_add_u32 s52, s52, s24
  s_lshl_b32 s3, s52, 5
  s_lshl_b32 s52, s52, 6
  v_lshrrev_b32 v2, 2, v0
  v_and_b32 v3, 3, v0
  v_mul_u32_u24 v200, 5120, v2
  v_lshl_add_u32 v200, v3, 4, v200
  v_lshrrev_b32 v2, 4, v0
  v_lshlrev_b32 v201, 3, v3
  v_lshl_add_u32 v201, v2, 1, v201
  s_mov_b32 s32, s4
  s_mov_b32 s33, s5
  s_mov_b32 s34, 2560
  s_mov_b32 s35, 0x20000
  buffer_load_ushort v202, v201, s[32:35], s3 offen
  s_add_u32 s14, s52, 1085440
  s_add_u32 s15, s52, 1167360
  s_add_u32 s18, s52, 823296
  v_mov_b32 v32, 0
  v_mov_b32 v33, 0
  v_mov_b32 v34, 0
  v_mov_b32 v35, 0
  s_waitcnt vmcnt(0)
  v_lshlrev_b32 v202, 16, v202
  s_mov_b32 s62, 2976190
L_lw_146:
  ds_read_b32 v14, v13 offset:10776
  s_waitcnt lgkmcnt(0)
  v_readfirstlane_b32 s63, v14
  s_cmp_ge_u32 s63, 4
  s_cbranch_scc1 L_lok_147
  s_sleep 4
  s_sub_u32 s62, s62, 1
  s_cmp_lg_u32 s62, 0
  s_cbranch_scc1 L_lw_146
L_lok_147:
  s_mov_b32 exec_hi, 0xffff
  s_mov_b32 s62, 2232142
  s_mov_b32 s66, 0x0c0c0400
  s_mov_b32 s67, 0x04000c0c
L_poll_148:
  buffer_load_dwordx4 v[32:35], v200, s[40:43], s18 offen sc1
  s_waitcnt vmcnt(0)
  v_perm_b32 v40, v33, v32, s66
  v_perm_b32 v41, v35, v34, s67
  v_or_b32 v40, v40, v41
  v_cmp_ne_u32 s[64:65], s30, v40
  s_cmp_eq_u64 s[64:65], 0
  s_cbranch_scc1 L_ok_149
  s_sleep 2
  s_sub_u32 s62, s62, 1
  s_cmp_lg_u32 s62, 0
  s_cbranch_scc1 L_poll_148
L_ok_149:
  v_and_b32 v32, 0xffffff00, v32
  v_and_b32 v33, 0xffffff00, v33
  v_and_b32 v34, 0xffffff00, v34
  v_and_b32 v35, 0xffffff00, v35
  s_mov_b32 exec_hi, -1
  v_permlane32_swap_b32 v32, v34
  v_permlane32_swap_b32 v33, v35
  v_pk_add_f32 v[32:33], v[32:33], v[34:35]
  s_nop 1
  v_permlane16_swap_b32 v32, v33
  v_add_f32 v32, v32, v33
  s_nop 1
  v_add_f32_dpp v32, v32, v32 row_ror:8 row_mask:0xf bank_mask:0xf
  s_nop 1
  v_add_f32_dpp v32, v32, v32 row_ror:4 row_mask:0xf bank_mask:0xf
  v_cvt_pk_bf16_f32 v32, v32, v32
  v_and_b32 v32, 0xffff0000, v32
  v_mul_f32 v36, 0xbfb8aa3b, v32
  v_exp_f32 v36, v36
  s_nop 0
  v_add_f32 v36, 1.0, v36
  v_rcp_f32 v36, v36
  s_nop 0
  v_mul_f32 v204, v32, v36
  v_cvt_pk_bf16_f32 v204, v204, v204
  v_and_b32 v204, 0xffff0000, v204
  s_mov_b32 s62, 2941176
  s_mov_b32 s66, 0x0c0c0400
  s_mov_b32 s67, 0x04000c0c
L_poll_150:
  buffer_load_dwordx4 v[16:19], v200, s[40:43], s14 offen sc1
  buffer_load_dwordx4 v[20:23], v200, s[40:43], s15 offen sc1
  s_waitcnt vmcnt(0)
  v_perm_b32 v40, v17, v16, s66
  v_perm_b32 v41, v19, v18, s67
  v_or_b32 v40, v40, v41
  v_cmp_ne_u32 s[64:65], s30, v40
  v_perm_b32 v40, v21, v20, s66
  v_perm_b32 v41, v23, v22, s67
  v_or_b32 v40, v40, v41
  v_cmp_ne_u32 vcc, s30, v40
  s_or_b64 s[64:65], s[64:65], vcc
  s_cmp_eq_u64 s[64:65], 0
  s_cbranch_scc1 L_ok_151
  s_sub_u32 s62, s62, 1
  s_cmp_lg_u32 s62, 0
  s_cbranch_scc1 L_poll_150
L_ok_151:
  v_and_b32 v16, 0xffffff00, v16
  v_and_b32 v17, 0xffffff00, v17
  v_and_b32 v18, 0xffffff00, v18
  v_and_b32 v19, 0xffffff00, v19
  v_and_b32 v20, 0xffffff00, v20
  v_and_b32 v21, 0xffffff00, v21
  v_and_b32 v22, 0xffffff00, v22
  v_and_b32 v23, 0xffffff00, v23
  v_pk_add_f32 v[16:17], v[16:17], v[20:21]
  v_pk_add_f32 v[18:19], v[18:19], v[22:23]
  s_nop 1
  v_permlane32_swap_b32 v16, v18
  v_permlane32_swap_b32 v17, v19
  v_pk_add_f32 v[16:17], v[16:17], v[18:19]
  s_nop 1
  v_permlane16_swap_b32 v16, v17
  v_add_f32 v16, v16, v17
  s_nop 1
  v_add_f32_dpp v16, v16, v16 row_ror:8 row_mask:0xf bank_mask:0xf
  s_nop 1
  v_add_f32_dpp v16, v16, v16 row_ror:4 row_mask:0xf bank_mask:0xf
  v_cvt_pk_bf16_f32 v16, v16, v16
  v_and_b32 v16, 0xffff0000, v16
  v_mul_f32 v16, v16, v204
  v_cvt_pk_bf16_f32 v16, v16, v16
  v_and_b32 v16, 0xffff0000, v16
  v_add_f32 v16, v16, v202
  v_cvt_pk_bf16_f32 v16, v16, v16
  s_mov_b32 exec_lo, 0x000f000f
  s_mov_b32 exec_hi, 0x000f000f
  buffer_store_short v16, v201, s[8:11], s3 offen
  s_cmp_lg_u32 s3, 0
  s_cbranch_scc1 L_fin
  s_mov_b64 exec, 1
  v_mov_b32 v22, s30
  v_mov_b32 v23, s31
  buffer_store_dwordx2 v[22:23], off, s[40:43], 0
L_fin:
L_end:
  s_endpgm
L_code_end:
.section .rodata,"a"
.p2align 6
.amdhsa_kernel recurrent_scan__mha_block_cached__dense_activation_relu__decode_kernel
  .amdhsa_next_free_vgpr 256
  .amdhsa_next_free_sgpr 102
  .amdhsa_accum_offset 256
  .amdhsa_group_segment_fixed_size 0
  .amdhsa_kernarg_size 88
  .amdhsa_user_sgpr_count 2
  .amdhsa_user_sgpr_kernarg_segment_ptr 1
  .amdhsa_system_sgpr_workgroup_id_x 1
.end_amdhsa_kernel
```
